```python
import torch

def _softmax(x, axis=-1):
    return torch.softmax(x, dim=axis)
def _gelu(x):
    return torch.nn.functional.gelu(x, approximate="tanh")
def _silu(x):
    return torch.nn.functional.silu(x)
def _sigmoid(x):
    return torch.sigmoid(x)
def _layernorm(x, axis=-1, eps=1e-5):
    m = x.mean(dim=axis, keepdim=True)
    v = x.var(dim=axis, keepdim=True, unbiased=False)
    return (x - m) / torch.sqrt(v + eps)
def _scatter_add(tgt, idx, src, axis=0):
    return tgt.clone().index_add_(axis, idx, src)
def _segment_sum(src, seg, n):
    out = torch.zeros((n,) + src.shape[1:], dtype=src.dtype)
    return out.index_add_(0, seg, src)
def _pad(x, pw):
    flat = tuple(v for pair in reversed(pw) for v in pair)
    return torch.nn.functional.pad(x, flat)

kernel_name = 'recurrent_scan__sliding_local_dilated__dense_activation_squared_relu__prompt'

def setup_inputs():

    _w = (lambda a: (lambda t: t.to(torch.bfloat16) if t.is_floating_point() else t)(torch.as_tensor(a)))
    def _A_setup():
        B, S, D = 1, 2048, 512
        return {
            "x": _w((lambda *s: torch.randn(*s, dtype=torch.bfloat16) * 0.05)(B, S, D)),
            "wqkv": _w((lambda *s: torch.randn(*s, dtype=torch.bfloat16) * 0.05)(D, 3 * D)),
            "wo": _w((lambda *s: torch.randn(*s, dtype=torch.bfloat16) * 0.05)(D, D)),
        }
    _A_in = _A_setup()

    def _B_setup():
        B, S, D, F = 1, 2048, 512, 1792
        return {
            "x": _w((lambda *s: torch.randn(*s, dtype=torch.bfloat16) * 0.05)(B, S, D)),
            "w1": _w((lambda *s: torch.randn(*s, dtype=torch.bfloat16) * 0.05)(D, F)),
            "b1": _w((lambda *s: torch.randn(*s, dtype=torch.bfloat16) * 0.4)(F)),
            "w2": _w((lambda *s: torch.randn(*s, dtype=torch.bfloat16) * 0.05)(F, D)),
            "b2": _w((lambda *s: torch.randn(*s, dtype=torch.bfloat16) * 0.8)(D)),
        }
    _B_in = _B_setup()

    return {
        "A_x": _A_in["x"],
        "A_wqkv": _A_in["wqkv"],
        "A_wo": _A_in["wo"],
        "B_x": _B_in["x"],
        "B_w1": _B_in["w1"],
        "B_b1": _B_in["b1"],
        "B_w2": _B_in["w2"],
        "B_b2": _B_in["b2"],
    }

def reference(A_x, A_wqkv, A_wo, B_x, B_w1, B_b1, B_w2, B_b2):
    def _A_ref(x, wqkv, wo):
        B, S, D = x.shape
        H = 32; Dh = D // H
        W, dil = 8, 2
        qkv = (lambda x, *d: x.permute(*d))((x @ wqkv).reshape(B, S, 3, H, Dh), 2, 0, 3, 1, 4)
        q, k, v = qkv[0], qkv[1], qkv[2]
        scale = Dh ** -0.5
        pos = torch.arange(S)
        off = torch.arange(W) * dil
        idx = pos[:, None] - off[None, :]
        mask = idx >= 0
        idx_c = torch.where(mask, idx, 0).reshape(-1)
        kg = k[:, :, idx_c, :].reshape(B, H, S, W, Dh)
        vg = v[:, :, idx_c, :].reshape(B, H, S, W, Dh)
        logits = torch.einsum("bhsd,bhswd->bhsw", q, kg) * scale
        logits = torch.where(mask[None, None, :, :], logits, -1e9)
        attn = _softmax(logits, axis=-1)
        o = torch.einsum("bhsw,bhswd->bhsd", attn, vg)
        return (lambda x, *d: x.permute(*d))(o, 0, 2, 1, 3).reshape(B, S, D) @ wo

    def _B_ref(x, w1, b1, w2, b2):
        h = torch.einsum("bsd,df->bsf", x, w1) + b1
        zero = torch.zeros_like(h)
        r = torch.where(h > zero, h, zero)
        h = r * r
        out = torch.einsum("bsf,fd->bsd", h, w2) + b2
        return out

    x = A_x
    xn = _layernorm(x, axis=-1)
    s = _A_ref(xn, A_wqkv, A_wo)
    g = _silu(_B_ref(xn, B_w1, B_b1, B_w2, B_b2))
    return x + s * g
```

```asm
; @launch grid=(256,1,1) block=(512,1,1) lds=163840
.amdgcn_target "amdgcn-amd-amdhsa--gfx950"
.text
.globl recurrent_scan__sliding_local_dilated__dense_activation_squared_relu__prompt_kernel
.p2align 8
.type recurrent_scan__sliding_local_dilated__dense_activation_squared_relu__prompt_kernel,@function
recurrent_scan__sliding_local_dilated__dense_activation_squared_relu__prompt_kernel:
  s_cmp_ge_u32 s2, 256
  s_cbranch_scc1 L_end
  s_load_dwordx16 s[8:23], s[0:1], 0
  s_load_dwordx4 s[24:27], s[0:1], 64
  s_load_dwordx2 s[28:29], s[0:1], 80
  s_getpc_b64 s[84:85]
L_cpf:
  v_lshrrev_b32 v7, 6, v0
  s_and_b32 s86, s2, 0xf8
  v_add_u32 v12, s86, v7
  v_and_b32 v11, 1, v0
  v_lshl_add_u32 v12, v12, 1, v11
  v_lshlrev_b32 v12, 7, v12
  v_min_u32 v12, L_codeend-L_cpf-4, v12
  global_load_dword v62, v12, s[84:85]
  v_and_b32 v1, 63, v0
  v_readfirstlane_b32 s56, v7
  s_and_b32 s84, s2, 7
  s_lshr_b32 s85, s2, 3
  s_and_b32 s58, s84, 3
  s_lshr_b32 s57, s84, 2
  s_lshl_b32 s98, s84, 5
  s_add_u32 s98, s98, s85
  s_and_b32 s100, s85, 1
  s_lshl_b32 s100, s100, 1
  s_add_u32 s100, s100, s57
  s_lshr_b32 s86, s85, 1
  s_and_b32 s87, s86, 1
  s_lshl_b32 s87, s87, 2
  s_add_u32 s87, s87, s58
  s_lshr_b32 s88, s86, 1
  s_lshl_b32 s88, s88, 3
  s_add_u32 s99, s87, s88
  s_sub_u32 s87, s86, 6
  s_and_b32 s88, s58, 1
  s_sub_u32 s88, 4, s88
  s_mul_i32 s89, s58, 7
  s_add_u32 s89, s89, 49
  s_lshr_b32 s89, s89, 1
  s_add_u32 s89, s89, s87
  s_sub_u32 s7, 14, s88
  s_cmp_ge_i32 s87, s88
  s_cselect_b32 s7, s7, 0
  s_add_u32 s89, s89, s7
  s_lshl_b32 s88, s88, 1
  s_cmp_ge_i32 s87, s88
  s_cselect_b32 s89, 52, s89
  s_cmp_ge_u32 s86, 6
  s_cselect_b32 s99, s89, s99
  s_cmp_ge_u32 s99, 24
  s_cselect_b32 s88, 512, 0
  s_cselect_b32 s89, 24, 0
  s_add_u32 s88, s88, 3072
  s_sub_u32 s89, s99, s89
  s_lshl_b32 s89, s89, 7
  s_lshl_b32 s87, s100, 3
  s_add_u32 s87, s87, s56
  s_lshl_b32 s87, s87, 4
  s_mul_i32 s87, s87, s88
  s_add_u32 s87, s87, s89
  v_and_b32 v8, 7, v1
  v_lshrrev_b32 v10, 3, v1
  v_lshlrev_b32 v15, 4, v1
  v_mul_u32_u24 v13, s88, v10
  v_lshl_add_u32 v13, v8, 4, v13
  s_lshl_b32 s46, s88, 9
  s_lshl_b32 s88, s88, 3
  s_add_u32 s88, s88, s87
  s_cmp_ge_u32 s99, 52
  s_cselect_b32 s46, 0, s46
  s_lshl_b32 s98, s98, 3
  s_add_u32 s98, s98, s56
  s_lshl_b32 s89, s98, 10
  s_mov_b32 s34, 0x200000
  s_mov_b32 s35, 0x20000
  s_mov_b32 s47, 0x20000
  s_lshl_b32 s57, s57, 3
  s_and_b32 s84, s85, 7
  s_add_u32 s57, s57, s84
  s_lshr_b32 s84, s85, 1
  s_and_b32 s84, s84, 12
  s_add_u32 s58, s58, s84
  s_and_b32 s60, s56, 3
  s_lshr_b32 s61, s56, 2
  v_lshrrev_b32 v9, 4, v1
  v_lshrrev_b32 v24, 5, v1
  s_cmp_ge_u32 s99, 24
  s_waitcnt lgkmcnt(0)
  s_mov_b32 s32, s8
  s_mov_b32 s33, s9
  s_cselect_b32 s44, s16, s10
  s_cselect_b32 s45, s17, s11
  buffer_load_dwordx4 v[32:35], v15, s[32:35], s89 offen
  buffer_load_dwordx4 v[36:39], v13, s[44:47], s87 offen
  buffer_load_dwordx4 v[40:43], v13, s[44:47], s88 offen
  s_cmp_ge_u32 s58, 8
  s_cbranch_scc0 L_qkv
  s_cmp_eq_u32 s61, 0
  s_cbranch_scc0 L_ffn_h1
  s_mov_b32 s36, s16
  s_mov_b32 s37, s17
  s_mov_b32 s38, 1835008
  s_mov_b32 s39, 0x20000
  s_movk_i32 s62, 3584
  s_movk_i32 s3, 14336
  v_xor_b32 v11, v8, v9
  v_lshlrev_b32 v11, 4, v11
  v_lshl_add_u32 v2, v10, 10, v11
  v_xor_b32 v3, 64, v2
  v_add_u32 v3, 8192, v3
  s_lshl_b32 s65, s56, 12
  s_lshl_b32 s63, s57, 3
  s_add_u32 s63, s63, s56
  s_lshl_b32 s63, s63, 14
  v_and_b32 v12, 15, v1
  v_lshlrev_b32 v13, 2, v9
  v_xor_b32 v12, v12, v13
  s_mul_i32 s88, s58, 448
  s_and_b32 s89, s58, 1
  s_lshl_b32 s89, s89, 6
  s_add_u32 s69, s88, s89
  s_sub_u32 s69, s69, 3584
  v_lshlrev_b32 v12, 4, v12
  v_mad_u32_u24 v4, v9, s62, v12
  s_mul_i32 s64, s56, 28672
  s_add_u32 s64, s64, s69
  s_mov_b32 s87, 10731520
  s_load_dword s73, s[28:29], s87
  s_mov_b32 s74, 0x3f803f80
  s_mov_b32 s75, 0x00003f80
  s_mov_b32 s76, 0x3f800000
  s_mov_b32 s40, s28
  s_mov_b32 s41, s29
  s_mov_b32 s42, 14155776
  s_mov_b32 s43, 0x20000
  v_and_b32 v14, 3, v1
  v_and_b32 v22, 1, v9
  v_lshlrev_b32 v26, 12, v22
  v_lshlrev_b32 v25, 2, v22
  v_xor_b32 v25, v25, v8
  v_lshlrev_b32 v59, 4, v25
  v_mov_b32 v60, v10
  v_lshl_add_u32 v7, v10, 10, v59
  v_lshlrev_b32 v22, 5, v22
  v_lshl_add_u32 v22, v14, 3, v22
  v_bfe_u32 v23, v1, 2, 2
  v_xor_b32 v25, 0, v23
  v_lshlrev_b32 v27, 12, v24
  v_lshl_add_u32 v27, v23, 8, v27
  v_add_u32 v27, v27, v22
  v_add_u32 v27, 2048, v27
  v_lshl_add_u32 v28, v25, 6, v27
  v_and_b32 v46, 1, v9
  v_lshrrev_b32 v47, 1, v9
  v_lshl_add_u32 v46, v46, 1, v47
  v_lshl_add_u32 v46, v8, 3, v46
  s_lshl_b32 s86, s56, 8
  s_add_u32 s86, s86, 159744
  v_lshl_add_u32 v46, v46, 2, s86
  v_and_b32 v27, 15, v1
  v_lshl_add_u32 v26, v27, 7, v26
  s_lshl_b32 s86, s60, 13
  v_add_u32 v26, s86, v26
  v_bfe_u32 v27, v1, 1, 3
  v_xor_b32 v27, v27, v24
  v_lshl_add_u32 v29, v27, 4, v26
  s_and_b32 s86, s2, 6
  s_lshr_b32 s87, s2, 3
  s_lshl_b32 s66, s86, 1
  s_and_b32 s86, s87, 3
  s_add_u32 s66, s66, s86
  s_bfe_u32 s67, s87, 0x10002
  s_lshr_b32 s68, s87, 3
  s_and_b32 s86, s2, 1
  s_lshl_b32 s86, s86, 2
  s_add_u32 s68, s68, s86
  s_add_u32 s70, s69, 256
  s_sub_u32 s87, s58, 8
  s_mul_i32 s88, s87, 448
  s_add_u32 s89, s88, 384
  s_mul_i32 s86, s87, 14
  s_add_u32 s86, s86, 32
  s_add_u32 s72, s86, 2
  s_add_u32 s82, s86, 12
  s_bitcmp1_b32 s58, 0
  s_cselect_b32 s71, s88, s89
  s_cselect_b32 s72, s72, s86
  s_cselect_b32 s82, s86, s82
  s_add_u32 s81, s72, 8
  v_mad_u32_u24 v5, v60, s62, v59
  v_lshrrev_b32 v56, 2, v1
  v_mul_u32_u24 v56, s62, v56
  v_and_b32 v57, 3, v1
  v_lshl_add_u32 v6, v57, 4, v56
  v_lshl_add_u32 v56, v24, 3, v23
  v_lshl_add_u32 v56, v56, 7, v22
  v_lshrrev_b32 v57, 1, v23
  v_lshl_add_u32 v14, v57, 6, v56
  s_lshl_b32 s86, s57, 2
  s_add_u32 s86, s86, s60
  s_mul_i32 s77, s86, 147456
  s_lshr_b32 s86, s86, 1
  s_lshl_b32 s86, s86, 3
  s_lshr_b32 s87, s58, 1
  s_add_u32 s86, s86, s87
  s_lshl_b32 s86, s86, 7
  s_and_b32 s87, s58, 1
  s_lshl_b32 s87, s87, 4
  s_add_u32 s86, s86, s87
  s_and_b32 s87, s60, 1
  s_lshl_b32 s87, s87, 3
  s_add_u32 s86, s86, s87
  s_add_u32 m0, s65, 2048
  s_add_u32 s80, s86, 10698752
  buffer_load_dwordx4 v4, s[36:39], s64 offen lds
  s_add_u32 m0, s65, 0
  s_nop 0
  buffer_load_dwordx4 v2, s[32:35], s63 offen lds
  s_add_u32 m0, s65, 3072
  s_add_u32 s64, s64, s3
  buffer_load_dwordx4 v4, s[36:39], s64 offen lds
  s_add_u32 m0, s65, 1024
  s_nop 0
  buffer_load_dwordx4 v3, s[32:35], s63 offen lds
  s_mov_b32 s4, 186368
  s_lshl_b32 s65, s60, 13
  s_lshl_b32 s63, s57, 2
  s_add_u32 s63, s63, s60
  s_lshl_b32 s63, s63, 15
  s_add_u32 s7, s63, 16384
  s_mul_i32 s64, s60, 57344
  s_add_u32 s64, s64, s69
  s_add_u32 s64, s64, 43008
  v_mov_b32 v12, v28
  v_xor_b32 v13, 64, v28
  v_mov_b32 v8, v29
  v_xor_b32 v9, 32, v29
  v_xor_b32 v10, 64, v29
  v_xor_b32 v11, 96, v29
  s_waitcnt vmcnt(6)
  v_dot2_f32_bf16 v44, v32, s74, 0
  v_dot2_f32_bf16 v45, v32, v32, 0
  v_dot2_f32_bf16 v44, v33, s74, v44
  v_dot2_f32_bf16 v45, v33, v33, v45
  v_dot2_f32_bf16 v44, v34, s74, v44
  v_dot2_f32_bf16 v45, v34, v34, v45
  v_dot2_f32_bf16 v44, v35, s74, v44
  v_dot2_f32_bf16 v45, v35, v35, v45
  s_waitcnt vmcnt(4)
  v_dot2_f32_bf16 v48, v36, s75, 0
  v_dot2_f32_bf16 v49, v36, s76, 0
  v_dot2_f32_bf16 v50, v37, s75, 0
  v_dot2_f32_bf16 v51, v37, s76, 0
  v_dot2_f32_bf16 v52, v38, s75, 0
  v_dot2_f32_bf16 v53, v38, s76, 0
  v_dot2_f32_bf16 v54, v39, s75, 0
  v_dot2_f32_bf16 v55, v39, s76, 0
  v_dot2_f32_bf16 v48, v40, s75, v48
  v_dot2_f32_bf16 v49, v40, s76, v49
  v_dot2_f32_bf16 v50, v41, s75, v50
  v_dot2_f32_bf16 v51, v41, s76, v51
  v_dot2_f32_bf16 v52, v42, s75, v52
  v_dot2_f32_bf16 v53, v42, s76, v53
  v_dot2_f32_bf16 v54, v43, s75, v54
  v_dot2_f32_bf16 v55, v43, s76, v55
  v_permlane32_swap_b32 v44, v45
  v_permlane32_swap_b32 v48, v49
  v_permlane32_swap_b32 v50, v51
  v_permlane32_swap_b32 v52, v53
  v_permlane32_swap_b32 v54, v55
  v_add_f32 v56, v44, v45
  v_add_f32 v48, v48, v49
  v_add_f32 v50, v50, v51
  v_add_f32 v52, v52, v53
  v_add_f32 v54, v54, v55
  v_mov_b32 v57, v56
  v_permlane16_swap_b32 v48, v50
  v_permlane16_swap_b32 v52, v54
  v_add_f32 v48, v48, v50
  v_add_f32 v52, v52, v54
  v_permlane16_swap_b32 v56, v57
  v_add_f32_dpp v48, v48, v48 row_ror:8 row_mask:0xf bank_mask:0xf
  v_add_f32_dpp v52, v52, v52 row_ror:8 row_mask:0xf bank_mask:0xf
  v_add_f32 v56, v56, v57
  ds_write2_b32 v46, v48, v52 offset0:0 offset1:4
  s_waitcnt lgkmcnt(0)
  s_mul_i32 s59, s73, 0x9E3779B1
  s_add_u32 s59, s59, 0x7F4A7C15
  s_and_b32 s59, s59, 0xfffffffc
  s_barrier
  v_add_f32_dpp v56, v56, v56 row_ror:8 row_mask:0xf bank_mask:0xf
  s_nop 1
  v_add_f32_dpp v56, v56, v56 row_ror:4 row_mask:0xf bank_mask:0xf
  s_lshl_b32 s88, s98, 3
  s_nop 0
  v_add_f32_dpp v56, v56, v56 row_ror:2 row_mask:0xf bank_mask:0xf
  s_add_u32 s88, s88, 10485760
  v_mov_b32 v117, s59
  v_add_f32_dpp v56, v56, v56 row_ror:1 row_mask:0xf bank_mask:0xf
  v_mov_b32 v112, 0x3b000000
  v_readlane_b32 s86, v56, 0
  v_readlane_b32 s87, v56, 32
  s_nop 0
  v_mul_f32 v113, s86, v112
  v_mul_f32 v114, s87, v112
  v_fma_f32 v114, -v113, v113, v114
  v_max_f32 v114, 0, v114
  v_cvt_pk_bf16_f32 v115, v113, v114
  v_and_b32 v115, 0xffff0000, v115
  v_add_f32 v115, 0x3727c5ac, v115
  v_cvt_pk_bf16_f32 v115, v115, v115
  v_and_b32 v115, 0xffff0000, v115
  v_sqrt_f32 v115, v115
  s_nop 0
  v_cvt_pk_bf16_f32 v116, v113, v115
  s_mov_b32 s98, s88
  s_add_u32 m0, s65, 34816
  s_add_u32 s64, s64, s4
  buffer_load_dwordx4 v4, s[36:39], s64 offen lds
  s_add_u32 m0, s65, 32768
  s_add_u32 s63, s63, 128
  buffer_load_dwordx4 v2, s[32:35], s63 offen lds
  s_add_u32 m0, s65, 35840
  s_add_u32 s64, s64, s3
  buffer_load_dwordx4 v4, s[36:39], s64 offen lds
  s_add_u32 m0, s65, 33792
  s_add_u32 s7, s7, 128
  buffer_load_dwordx4 v3, s[32:35], s63 offen lds
  s_add_u32 m0, s65, 38912
  s_add_u32 s64, s64, s3
  buffer_load_dwordx4 v4, s[36:39], s64 offen lds
  s_add_u32 m0, s65, 36864
  s_nop 0
  buffer_load_dwordx4 v2, s[32:35], s7 offen lds
  s_add_u32 m0, s65, 39936
  s_add_u32 s64, s64, s3
  buffer_load_dwordx4 v4, s[36:39], s64 offen lds
  s_add_u32 m0, s65, 37888
  s_nop 0
  buffer_load_dwordx4 v3, s[32:35], s7 offen lds
  s_add_u32 m0, s65, 67584
  s_add_u32 s64, s64, s4
  buffer_load_dwordx4 v4, s[36:39], s64 offen lds
  s_add_u32 m0, s65, 65536
  s_add_u32 s63, s63, 128
  buffer_load_dwordx4 v2, s[32:35], s63 offen lds
  s_add_u32 m0, s65, 68608
  s_add_u32 s64, s64, s3
  buffer_load_dwordx4 v4, s[36:39], s64 offen lds
  s_add_u32 m0, s65, 66560
  s_add_u32 s7, s7, 128
  buffer_load_dwordx4 v3, s[32:35], s63 offen lds
  s_add_u32 m0, s65, 71680
  s_add_u32 s64, s64, s3
  buffer_load_dwordx4 v4, s[36:39], s64 offen lds
  s_add_u32 m0, s65, 69632
  s_nop 0
  buffer_load_dwordx4 v2, s[32:35], s7 offen lds
  s_add_u32 m0, s65, 72704
  s_add_u32 s64, s64, s3
  buffer_load_dwordx4 v4, s[36:39], s64 offen lds
  s_add_u32 m0, s65, 70656
  s_nop 0
  buffer_load_dwordx4 v3, s[32:35], s7 offen lds
  s_waitcnt vmcnt(16)
  s_barrier
  ds_read_b64_tr_b16 v[32:33], v12 offset:0
  ds_read_b64_tr_b16 v[34:35], v12 offset:1024
  ds_read_b128 v[128:131], v8 offset:0
  ds_read_b64_tr_b16 v[36:37], v13 offset:0
  ds_read_b64_tr_b16 v[38:39], v13 offset:1024
  s_waitcnt lgkmcnt(0)
  v_mfma_f32_32x32x16_bf16 v[64:79], v[32:35], v[128:131], 0
  s_add_u32 m0, s65, 100352
  s_add_u32 s64, s64, s4
  buffer_load_dwordx4 v4, s[36:39], s64 offen lds
  ds_read_b64_tr_b16 v[40:41], v12 offset:8192
  ds_read_b64_tr_b16 v[42:43], v12 offset:9216
  ds_read_b128 v[132:135], v9 offset:0
  ds_read_b64_tr_b16 v[44:45], v13 offset:8192
  ds_read_b64_tr_b16 v[46:47], v13 offset:9216
  v_mfma_f32_32x32x16_bf16 v[80:95], v[36:39], v[128:131], 0
  s_add_u32 m0, s65, 98304
  s_add_u32 s63, s63, 128
  buffer_load_dwordx4 v2, s[32:35], s63 offen lds
  s_mov_b64 exec, 1
  buffer_store_dwordx2 v[116:117], off, s[40:43], s98 sc1
  s_mov_b64 exec, -1
  s_waitcnt lgkmcnt(0)
  v_mfma_f32_32x32x16_bf16 v[64:79], v[40:43], v[132:135], v[64:79]
  s_add_u32 m0, s65, 101376
  s_add_u32 s64, s64, s3
  buffer_load_dwordx4 v4, s[36:39], s64 offen lds
  ds_read_b64_tr_b16 v[32:33], v12 offset:16384
  ds_read_b64_tr_b16 v[34:35], v12 offset:17408
  ds_read_b128 v[136:139], v10 offset:0
  ds_read_b64_tr_b16 v[36:37], v13 offset:16384
  ds_read_b64_tr_b16 v[38:39], v13 offset:17408
  v_mfma_f32_32x32x16_bf16 v[80:95], v[44:47], v[132:135], v[80:95]
  s_add_u32 m0, s65, 99328
  s_add_u32 s7, s7, 128
  buffer_load_dwordx4 v3, s[32:35], s63 offen lds
  s_waitcnt lgkmcnt(0)
  v_mfma_f32_32x32x16_bf16 v[64:79], v[32:35], v[136:139], v[64:79]
  s_add_u32 m0, s65, 104448
  s_add_u32 s64, s64, s3
  buffer_load_dwordx4 v4, s[36:39], s64 offen lds
  ds_read_b64_tr_b16 v[40:41], v12 offset:24576
  ds_read_b64_tr_b16 v[42:43], v12 offset:25600
  ds_read_b128 v[140:143], v11 offset:0
  ds_read_b64_tr_b16 v[44:45], v13 offset:24576
  ds_read_b64_tr_b16 v[46:47], v13 offset:25600
  v_mfma_f32_32x32x16_bf16 v[80:95], v[36:39], v[136:139], v[80:95]
  s_add_u32 m0, s65, 102400
  s_nop 0
  buffer_load_dwordx4 v2, s[32:35], s7 offen lds
  s_waitcnt vmcnt(15)
  s_barrier
  s_waitcnt lgkmcnt(0)
  v_mfma_f32_32x32x16_bf16 v[64:79], v[40:43], v[140:143], v[64:79]
  s_add_u32 m0, s65, 105472
  s_add_u32 s64, s64, s3
  buffer_load_dwordx4 v4, s[36:39], s64 offen lds
  ds_read_b64_tr_b16 v[32:33], v12 offset:32768
  ds_read_b64_tr_b16 v[34:35], v12 offset:33792
  ds_read_b128 v[144:147], v8 offset:32768
  ds_read_b64_tr_b16 v[36:37], v13 offset:32768
  ds_read_b64_tr_b16 v[38:39], v13 offset:33792
  v_mfma_f32_32x32x16_bf16 v[80:95], v[44:47], v[140:143], v[80:95]
  s_add_u32 m0, s65, 103424
  s_nop 0
  buffer_load_dwordx4 v3, s[32:35], s7 offen lds
  s_waitcnt lgkmcnt(0)
  v_mfma_f32_32x32x16_bf16 v[64:79], v[32:35], v[144:147], v[64:79]
  ds_read_b64_tr_b16 v[40:41], v12 offset:40960
  ds_read_b64_tr_b16 v[42:43], v12 offset:41984
  ds_read_b128 v[148:151], v9 offset:32768
  ds_read_b64_tr_b16 v[44:45], v13 offset:40960
  ds_read_b64_tr_b16 v[46:47], v13 offset:41984
  v_mfma_f32_32x32x16_bf16 v[80:95], v[36:39], v[144:147], v[80:95]
  s_waitcnt lgkmcnt(0)
  v_mfma_f32_32x32x16_bf16 v[64:79], v[40:43], v[148:151], v[64:79]
  ds_read_b64_tr_b16 v[32:33], v12 offset:49152
  ds_read_b64_tr_b16 v[34:35], v12 offset:50176
  ds_read_b128 v[152:155], v10 offset:32768
  ds_read_b64_tr_b16 v[36:37], v13 offset:49152
  ds_read_b64_tr_b16 v[38:39], v13 offset:50176
  v_mfma_f32_32x32x16_bf16 v[80:95], v[44:47], v[148:151], v[80:95]
  s_waitcnt lgkmcnt(0)
  v_mfma_f32_32x32x16_bf16 v[64:79], v[32:35], v[152:155], v[64:79]
  ds_read_b64_tr_b16 v[40:41], v12 offset:57344
  ds_read_b64_tr_b16 v[42:43], v12 offset:58368
  ds_read_b128 v[156:159], v11 offset:32768
  ds_read_b64_tr_b16 v[44:45], v13 offset:57344
  ds_read_b64_tr_b16 v[46:47], v13 offset:58368
  v_mfma_f32_32x32x16_bf16 v[80:95], v[36:39], v[152:155], v[80:95]
  s_waitcnt vmcnt(9)
  s_barrier
  s_waitcnt lgkmcnt(0)
  v_mfma_f32_32x32x16_bf16 v[64:79], v[40:43], v[156:159], v[64:79]
  s_add_u32 m0, s65, 2048
  s_add_u32 s64, s64, s4
  buffer_load_dwordx4 v4, s[36:39], s64 offen lds
  s_add_u32 m0, s65, 0
  s_add_u32 s63, s63, 128
  buffer_load_dwordx4 v2, s[32:35], s63 offen lds
  v_xor_b32 v8, 0x10000, v8
  v_xor_b32 v9, 0x10000, v9
  v_xor_b32 v10, 0x10000, v10
  v_xor_b32 v11, 0x10000, v11
  v_xor_b32 v12, 0x10000, v12
  v_xor_b32 v13, 0x10000, v13
  ds_read_b64_tr_b16 v[32:33], v12 offset:0
  ds_read_b64_tr_b16 v[34:35], v12 offset:1024
  ds_read_b128 v[160:163], v8 offset:0
  ds_read_b64_tr_b16 v[36:37], v13 offset:0
  ds_read_b64_tr_b16 v[38:39], v13 offset:1024
  v_mfma_f32_32x32x16_bf16 v[80:95], v[44:47], v[156:159], v[80:95]
  s_add_u32 m0, s65, 3072
  s_add_u32 s64, s64, s3
  buffer_load_dwordx4 v4, s[36:39], s64 offen lds
  s_add_u32 m0, s65, 1024
  s_add_u32 s7, s7, 128
  buffer_load_dwordx4 v3, s[32:35], s63 offen lds
  s_waitcnt lgkmcnt(0)
  v_mfma_f32_32x32x16_bf16 v[64:79], v[32:35], v[160:163], v[64:79]
  s_add_u32 m0, s65, 6144
  s_add_u32 s64, s64, s3
  buffer_load_dwordx4 v4, s[36:39], s64 offen lds
  s_add_u32 m0, s65, 4096
  s_nop 0
  buffer_load_dwordx4 v2, s[32:35], s7 offen lds
  ds_read_b64_tr_b16 v[40:41], v12 offset:8192
  ds_read_b64_tr_b16 v[42:43], v12 offset:9216
  ds_read_b128 v[164:167], v9 offset:0
  ds_read_b64_tr_b16 v[44:45], v13 offset:8192
  ds_read_b64_tr_b16 v[46:47], v13 offset:9216
  v_mfma_f32_32x32x16_bf16 v[80:95], v[36:39], v[160:163], v[80:95]
  s_add_u32 m0, s65, 7168
  s_add_u32 s64, s64, s3
  buffer_load_dwordx4 v4, s[36:39], s64 offen lds
  s_add_u32 m0, s65, 5120
  s_nop 0
  buffer_load_dwordx4 v3, s[32:35], s7 offen lds
  s_waitcnt lgkmcnt(0)
  v_mfma_f32_32x32x16_bf16 v[64:79], v[40:43], v[164:167], v[64:79]
  ds_read_b64_tr_b16 v[32:33], v12 offset:16384
  ds_read_b64_tr_b16 v[34:35], v12 offset:17408
  ds_read_b128 v[168:171], v10 offset:0
  ds_read_b64_tr_b16 v[36:37], v13 offset:16384
  ds_read_b64_tr_b16 v[38:39], v13 offset:17408
  v_mfma_f32_32x32x16_bf16 v[80:95], v[44:47], v[164:167], v[80:95]
  s_waitcnt lgkmcnt(0)
  v_mfma_f32_32x32x16_bf16 v[64:79], v[32:35], v[168:171], v[64:79]
  ds_read_b64_tr_b16 v[40:41], v12 offset:24576
  ds_read_b64_tr_b16 v[42:43], v12 offset:25600
  ds_read_b128 v[172:175], v11 offset:0
  ds_read_b64_tr_b16 v[44:45], v13 offset:24576
  ds_read_b64_tr_b16 v[46:47], v13 offset:25600
  v_mfma_f32_32x32x16_bf16 v[80:95], v[36:39], v[168:171], v[80:95]
  s_waitcnt vmcnt(8)
  s_barrier
  s_waitcnt lgkmcnt(0)
  v_mfma_f32_32x32x16_bf16 v[64:79], v[40:43], v[172:175], v[64:79]
  s_add_u32 m0, s65, 34816
  s_add_u32 s64, s64, s4
  buffer_load_dwordx4 v4, s[36:39], s64 offen lds
  s_add_u32 m0, s65, 32768
  s_add_u32 s63, s63, 128
  buffer_load_dwordx4 v2, s[32:35], s63 offen lds
  ds_read_b64_tr_b16 v[32:33], v12 offset:32768
  ds_read_b64_tr_b16 v[34:35], v12 offset:33792
  ds_read_b128 v[176:179], v8 offset:32768
  ds_read_b64_tr_b16 v[36:37], v13 offset:32768
  ds_read_b64_tr_b16 v[38:39], v13 offset:33792
  v_mfma_f32_32x32x16_bf16 v[80:95], v[44:47], v[172:175], v[80:95]
  s_add_u32 m0, s65, 35840
  s_add_u32 s64, s64, s3
  buffer_load_dwordx4 v4, s[36:39], s64 offen lds
  s_add_u32 m0, s65, 33792
  s_add_u32 s7, s7, 128
  buffer_load_dwordx4 v3, s[32:35], s63 offen lds
  s_waitcnt lgkmcnt(0)
  v_mfma_f32_32x32x16_bf16 v[64:79], v[32:35], v[176:179], v[64:79]
  s_add_u32 m0, s65, 38912
  s_add_u32 s64, s64, s3
  buffer_load_dwordx4 v4, s[36:39], s64 offen lds
  s_add_u32 m0, s65, 36864
  s_nop 0
  buffer_load_dwordx4 v2, s[32:35], s7 offen lds
  ds_read_b64_tr_b16 v[40:41], v12 offset:40960
  ds_read_b64_tr_b16 v[42:43], v12 offset:41984
  ds_read_b128 v[180:183], v9 offset:32768
  ds_read_b64_tr_b16 v[44:45], v13 offset:40960
  ds_read_b64_tr_b16 v[46:47], v13 offset:41984
  v_mfma_f32_32x32x16_bf16 v[80:95], v[36:39], v[176:179], v[80:95]
  s_add_u32 m0, s65, 39936
  s_add_u32 s64, s64, s3
  buffer_load_dwordx4 v4, s[36:39], s64 offen lds
  s_add_u32 m0, s65, 37888
  s_nop 0
  buffer_load_dwordx4 v3, s[32:35], s7 offen lds
  s_waitcnt lgkmcnt(0)
  v_mfma_f32_32x32x16_bf16 v[64:79], v[40:43], v[180:183], v[64:79]
  ds_read_b64_tr_b16 v[32:33], v12 offset:49152
  ds_read_b64_tr_b16 v[34:35], v12 offset:50176
  ds_read_b128 v[184:187], v10 offset:32768
  ds_read_b64_tr_b16 v[36:37], v13 offset:49152
  ds_read_b64_tr_b16 v[38:39], v13 offset:50176
  v_mfma_f32_32x32x16_bf16 v[80:95], v[44:47], v[180:183], v[80:95]
  s_waitcnt lgkmcnt(0)
  v_mfma_f32_32x32x16_bf16 v[64:79], v[32:35], v[184:187], v[64:79]
  ds_read_b64_tr_b16 v[40:41], v12 offset:57344
  ds_read_b64_tr_b16 v[42:43], v12 offset:58368
  ds_read_b128 v[188:191], v11 offset:32768
  ds_read_b64_tr_b16 v[44:45], v13 offset:57344
  ds_read_b64_tr_b16 v[46:47], v13 offset:58368
  v_mfma_f32_32x32x16_bf16 v[80:95], v[36:39], v[184:187], v[80:95]
  s_waitcnt vmcnt(8)
  s_barrier
  s_waitcnt lgkmcnt(0)
  v_mfma_f32_32x32x16_bf16 v[64:79], v[40:43], v[188:191], v[64:79]
  s_add_u32 m0, s65, 67584
  s_add_u32 s64, s64, s4
  buffer_load_dwordx4 v4, s[36:39], s64 offen lds
  s_add_u32 m0, s65, 65536
  s_add_u32 s63, s63, 128
  buffer_load_dwordx4 v2, s[32:35], s63 offen lds
  v_xor_b32 v8, 0x10000, v8
  v_xor_b32 v9, 0x10000, v9
  v_xor_b32 v10, 0x10000, v10
  v_xor_b32 v11, 0x10000, v11
  v_xor_b32 v12, 0x10000, v12
  v_xor_b32 v13, 0x10000, v13
  ds_read_b64_tr_b16 v[32:33], v12 offset:0
  ds_read_b64_tr_b16 v[34:35], v12 offset:1024
  ds_read_b128 v[192:195], v8 offset:0
  ds_read_b64_tr_b16 v[36:37], v13 offset:0
  ds_read_b64_tr_b16 v[38:39], v13 offset:1024
  v_mfma_f32_32x32x16_bf16 v[80:95], v[44:47], v[188:191], v[80:95]
  s_add_u32 m0, s65, 68608
  s_add_u32 s64, s64, s3
  buffer_load_dwordx4 v4, s[36:39], s64 offen lds
  s_add_u32 m0, s65, 66560
  s_add_u32 s7, s7, 128
  buffer_load_dwordx4 v3, s[32:35], s63 offen lds
  s_waitcnt lgkmcnt(0)
  v_mfma_f32_32x32x16_bf16 v[64:79], v[32:35], v[192:195], v[64:79]
  s_add_u32 m0, s65, 71680
  s_add_u32 s64, s64, s3
  buffer_load_dwordx4 v4, s[36:39], s64 offen lds
  s_add_u32 m0, s65, 69632
  s_nop 0
  buffer_load_dwordx4 v2, s[32:35], s7 offen lds
  ds_read_b64_tr_b16 v[40:41], v12 offset:8192
  ds_read_b64_tr_b16 v[42:43], v12 offset:9216
  ds_read_b128 v[196:199], v9 offset:0
  ds_read_b64_tr_b16 v[44:45], v13 offset:8192
  ds_read_b64_tr_b16 v[46:47], v13 offset:9216
  v_mfma_f32_32x32x16_bf16 v[80:95], v[36:39], v[192:195], v[80:95]
  s_add_u32 m0, s65, 72704
  s_add_u32 s64, s64, s3
  buffer_load_dwordx4 v4, s[36:39], s64 offen lds
  s_add_u32 m0, s65, 70656
  s_nop 0
  buffer_load_dwordx4 v3, s[32:35], s7 offen lds
  s_waitcnt lgkmcnt(0)
  v_mfma_f32_32x32x16_bf16 v[64:79], v[40:43], v[196:199], v[64:79]
  ds_read_b64_tr_b16 v[32:33], v12 offset:16384
  ds_read_b64_tr_b16 v[34:35], v12 offset:17408
  ds_read_b128 v[200:203], v10 offset:0
  ds_read_b64_tr_b16 v[36:37], v13 offset:16384
  ds_read_b64_tr_b16 v[38:39], v13 offset:17408
  v_mfma_f32_32x32x16_bf16 v[80:95], v[44:47], v[196:199], v[80:95]
  s_waitcnt lgkmcnt(0)
  v_mfma_f32_32x32x16_bf16 v[64:79], v[32:35], v[200:203], v[64:79]
  ds_read_b64_tr_b16 v[40:41], v12 offset:24576
  ds_read_b64_tr_b16 v[42:43], v12 offset:25600
  ds_read_b128 v[204:207], v11 offset:0
  ds_read_b64_tr_b16 v[44:45], v13 offset:24576
  ds_read_b64_tr_b16 v[46:47], v13 offset:25600
  v_mfma_f32_32x32x16_bf16 v[80:95], v[36:39], v[200:203], v[80:95]
  s_waitcnt vmcnt(8)
  s_barrier
  s_waitcnt lgkmcnt(0)
  v_mfma_f32_32x32x16_bf16 v[64:79], v[40:43], v[204:207], v[64:79]
  s_add_u32 m0, s65, 100352
  s_add_u32 s64, s64, s4
  buffer_load_dwordx4 v4, s[36:39], s64 offen lds
  s_add_u32 m0, s65, 98304
  s_add_u32 s63, s63, 128
  buffer_load_dwordx4 v2, s[32:35], s63 offen lds
  ds_read_b64_tr_b16 v[32:33], v12 offset:32768
  ds_read_b64_tr_b16 v[34:35], v12 offset:33792
  ds_read_b128 v[208:211], v8 offset:32768
  ds_read_b64_tr_b16 v[36:37], v13 offset:32768
  ds_read_b64_tr_b16 v[38:39], v13 offset:33792
  v_mfma_f32_32x32x16_bf16 v[80:95], v[44:47], v[204:207], v[80:95]
  s_add_u32 m0, s65, 101376
  s_add_u32 s64, s64, s3
  buffer_load_dwordx4 v4, s[36:39], s64 offen lds
  s_add_u32 m0, s65, 99328
  s_add_u32 s7, s7, 128
  buffer_load_dwordx4 v3, s[32:35], s63 offen lds
  s_waitcnt lgkmcnt(0)
  v_mfma_f32_32x32x16_bf16 v[64:79], v[32:35], v[208:211], v[64:79]
  s_add_u32 m0, s65, 104448
  s_add_u32 s64, s64, s3
  buffer_load_dwordx4 v4, s[36:39], s64 offen lds
  s_add_u32 m0, s65, 102400
  s_nop 0
  buffer_load_dwordx4 v2, s[32:35], s7 offen lds
  ds_read_b64_tr_b16 v[40:41], v12 offset:40960
  ds_read_b64_tr_b16 v[42:43], v12 offset:41984
  ds_read_b128 v[212:215], v9 offset:32768
  ds_read_b64_tr_b16 v[44:45], v13 offset:40960
  ds_read_b64_tr_b16 v[46:47], v13 offset:41984
  v_mfma_f32_32x32x16_bf16 v[80:95], v[36:39], v[208:211], v[80:95]
  s_add_u32 m0, s65, 105472
  s_add_u32 s64, s64, s3
  buffer_load_dwordx4 v4, s[36:39], s64 offen lds
  s_add_u32 m0, s65, 103424
  s_nop 0
  buffer_load_dwordx4 v3, s[32:35], s7 offen lds
  s_waitcnt lgkmcnt(0)
  v_mfma_f32_32x32x16_bf16 v[64:79], v[40:43], v[212:215], v[64:79]
  ds_read_b64_tr_b16 v[32:33], v12 offset:49152
  ds_read_b64_tr_b16 v[34:35], v12 offset:50176
  ds_read_b128 v[216:219], v10 offset:32768
  ds_read_b64_tr_b16 v[36:37], v13 offset:49152
  ds_read_b64_tr_b16 v[38:39], v13 offset:50176
  v_mfma_f32_32x32x16_bf16 v[80:95], v[44:47], v[212:215], v[80:95]
  s_waitcnt lgkmcnt(0)
  v_mfma_f32_32x32x16_bf16 v[64:79], v[32:35], v[216:219], v[64:79]
  ds_read_b64_tr_b16 v[40:41], v12 offset:57344
  ds_read_b64_tr_b16 v[42:43], v12 offset:58368
  ds_read_b128 v[220:223], v11 offset:32768
  ds_read_b64_tr_b16 v[44:45], v13 offset:57344
  ds_read_b64_tr_b16 v[46:47], v13 offset:58368
  v_mfma_f32_32x32x16_bf16 v[80:95], v[36:39], v[216:219], v[80:95]
  s_waitcnt vmcnt(8)
  s_barrier
  s_waitcnt lgkmcnt(0)
  v_mfma_f32_32x32x16_bf16 v[64:79], v[40:43], v[220:223], v[64:79]
  s_add_u32 s5, s60, 0
  s_add_u32 s5, s5, 0
  s_and_b32 s5, s5, 7
  s_lshl_b32 s5, s5, 6
  s_mul_i32 s5, s5, s62
  s_add_u32 s5, s5, s70
  s_add_u32 m0, s65, 0
  s_lshl_b32 s7, s62, 3
  buffer_load_dwordx4 v5, s[36:39], s5 offen lds
  s_add_u32 m0, s65, 1024
  s_add_u32 s5, s5, s7
  buffer_load_dwordx4 v5, s[36:39], s5 offen lds
  v_xor_b32 v8, 0x10000, v8
  v_xor_b32 v9, 0x10000, v9
  v_xor_b32 v10, 0x10000, v10
  v_xor_b32 v11, 0x10000, v11
  v_xor_b32 v12, 0x10000, v12
  v_xor_b32 v13, 0x10000, v13
  ds_read_b64_tr_b16 v[32:33], v12 offset:0
  ds_read_b64_tr_b16 v[34:35], v12 offset:1024
  ds_read_b128 v[224:227], v8 offset:0
  ds_read_b64_tr_b16 v[36:37], v13 offset:0
  ds_read_b64_tr_b16 v[38:39], v13 offset:1024
  v_mfma_f32_32x32x16_bf16 v[80:95], v[44:47], v[220:223], v[80:95]
  s_add_u32 m0, s65, 2048
  s_add_u32 s5, s5, s7
  buffer_load_dwordx4 v5, s[36:39], s5 offen lds
  s_add_u32 m0, s65, 3072
  s_add_u32 s5, s5, s7
  buffer_load_dwordx4 v5, s[36:39], s5 offen lds
  s_waitcnt lgkmcnt(0)
  v_mfma_f32_32x32x16_bf16 v[64:79], v[32:35], v[224:227], v[64:79]
  s_add_u32 m0, s65, 4096
  s_add_u32 s5, s5, s7
  buffer_load_dwordx4 v5, s[36:39], s5 offen lds
  s_add_u32 m0, s65, 5120
  s_add_u32 s5, s5, s7
  buffer_load_dwordx4 v5, s[36:39], s5 offen lds
  ds_read_b64_tr_b16 v[40:41], v12 offset:8192
  ds_read_b64_tr_b16 v[42:43], v12 offset:9216
  ds_read_b128 v[228:231], v9 offset:0
  ds_read_b64_tr_b16 v[44:45], v13 offset:8192
  ds_read_b64_tr_b16 v[46:47], v13 offset:9216
  v_mfma_f32_32x32x16_bf16 v[80:95], v[36:39], v[224:227], v[80:95]
  s_add_u32 m0, s65, 6144
  s_add_u32 s5, s5, s7
  buffer_load_dwordx4 v5, s[36:39], s5 offen lds
  s_add_u32 m0, s65, 7168
  s_add_u32 s5, s5, s7
  buffer_load_dwordx4 v5, s[36:39], s5 offen lds
  s_waitcnt lgkmcnt(0)
  v_mfma_f32_32x32x16_bf16 v[64:79], v[40:43], v[228:231], v[64:79]
  ds_read_b64_tr_b16 v[32:33], v12 offset:16384
  ds_read_b64_tr_b16 v[34:35], v12 offset:17408
  ds_read_b128 v[232:235], v10 offset:0
  ds_read_b64_tr_b16 v[36:37], v13 offset:16384
  ds_read_b64_tr_b16 v[38:39], v13 offset:17408
  v_mfma_f32_32x32x16_bf16 v[80:95], v[44:47], v[228:231], v[80:95]
  s_waitcnt lgkmcnt(0)
  v_mfma_f32_32x32x16_bf16 v[64:79], v[32:35], v[232:235], v[64:79]
  ds_read_b64_tr_b16 v[40:41], v12 offset:24576
  ds_read_b64_tr_b16 v[42:43], v12 offset:25600
  ds_read_b128 v[236:239], v11 offset:0
  ds_read_b64_tr_b16 v[44:45], v13 offset:24576
  ds_read_b64_tr_b16 v[46:47], v13 offset:25600
  v_mfma_f32_32x32x16_bf16 v[80:95], v[36:39], v[232:235], v[80:95]
  s_waitcnt vmcnt(8)
  s_barrier
  s_waitcnt lgkmcnt(0)
  v_mfma_f32_32x32x16_bf16 v[64:79], v[40:43], v[236:239], v[64:79]
  s_add_u32 s5, s60, 4
  s_add_u32 s5, s5, 0
  s_and_b32 s5, s5, 7
  s_lshl_b32 s5, s5, 6
  s_mul_i32 s5, s5, s62
  s_add_u32 s5, s5, s70
  s_add_u32 m0, s65, 32768
  s_lshl_b32 s7, s62, 3
  buffer_load_dwordx4 v5, s[36:39], s5 offen lds
  s_add_u32 m0, s65, 33792
  s_add_u32 s5, s5, s7
  buffer_load_dwordx4 v5, s[36:39], s5 offen lds
  ds_read_b64_tr_b16 v[32:33], v12 offset:32768
  ds_read_b64_tr_b16 v[34:35], v12 offset:33792
  ds_read_b128 v[240:243], v8 offset:32768
  ds_read_b64_tr_b16 v[36:37], v13 offset:32768
  ds_read_b64_tr_b16 v[38:39], v13 offset:33792
  v_mfma_f32_32x32x16_bf16 v[80:95], v[44:47], v[236:239], v[80:95]
  s_add_u32 m0, s65, 34816
  s_add_u32 s5, s5, s7
  buffer_load_dwordx4 v5, s[36:39], s5 offen lds
  s_add_u32 m0, s65, 35840
  s_add_u32 s5, s5, s7
  buffer_load_dwordx4 v5, s[36:39], s5 offen lds
  s_waitcnt lgkmcnt(0)
  v_mfma_f32_32x32x16_bf16 v[64:79], v[32:35], v[240:243], v[64:79]
  s_add_u32 m0, s65, 36864
  s_add_u32 s5, s5, s7
  buffer_load_dwordx4 v5, s[36:39], s5 offen lds
  s_add_u32 m0, s65, 37888
  s_add_u32 s5, s5, s7
  buffer_load_dwordx4 v5, s[36:39], s5 offen lds
  ds_read_b64_tr_b16 v[40:41], v12 offset:40960
  ds_read_b64_tr_b16 v[42:43], v12 offset:41984
  ds_read_b128 v[244:247], v9 offset:32768
  ds_read_b64_tr_b16 v[44:45], v13 offset:40960
  ds_read_b64_tr_b16 v[46:47], v13 offset:41984
  v_mfma_f32_32x32x16_bf16 v[80:95], v[36:39], v[240:243], v[80:95]
  s_add_u32 m0, s65, 38912
  s_add_u32 s5, s5, s7
  buffer_load_dwordx4 v5, s[36:39], s5 offen lds
  s_add_u32 m0, s65, 39936
  s_add_u32 s5, s5, s7
  buffer_load_dwordx4 v5, s[36:39], s5 offen lds
  s_waitcnt lgkmcnt(0)
  v_mfma_f32_32x32x16_bf16 v[64:79], v[40:43], v[244:247], v[64:79]
  ds_read_b64_tr_b16 v[32:33], v12 offset:49152
  ds_read_b64_tr_b16 v[34:35], v12 offset:50176
  ds_read_b128 v[248:251], v10 offset:32768
  ds_read_b64_tr_b16 v[36:37], v13 offset:49152
  ds_read_b64_tr_b16 v[38:39], v13 offset:50176
  v_mfma_f32_32x32x16_bf16 v[80:95], v[44:47], v[244:247], v[80:95]
  s_waitcnt lgkmcnt(0)
  v_mfma_f32_32x32x16_bf16 v[64:79], v[32:35], v[248:251], v[64:79]
  ds_read_b64_tr_b16 v[40:41], v12 offset:57344
  ds_read_b64_tr_b16 v[42:43], v12 offset:58368
  ds_read_b128 v[252:255], v11 offset:32768
  ds_read_b64_tr_b16 v[44:45], v13 offset:57344
  ds_read_b64_tr_b16 v[46:47], v13 offset:58368
  v_mfma_f32_32x32x16_bf16 v[80:95], v[36:39], v[248:251], v[80:95]
  s_barrier
  v_and_b32 v126, 31, v1
  v_lshlrev_b32 v127, 3, v126
  v_add_u32 v127, 159744, v127
  v_mov_b32 v24, 0
  v_mov_b32 v25, 0
  v_mov_b32 v28, 0
  v_mov_b32 v29, 0
  s_lshl_b32 s84, s60, 7
  s_add_u32 s84, s84, 161792
  v_lshl_add_u32 v126, v126, 2, s84
  ds_read_b32 v125, v126
  ds_read_b64 v[22:23], v127 offset:0
  ds_read_b64 v[26:27], v127 offset:256
  ds_read_b64 v[60:61], v127 offset:1024
  ds_read_b64 v[58:59], v127 offset:1280
  ds_read_b64 v[30:31], v127 offset:1536
  s_waitcnt lgkmcnt(6)
  v_mfma_f32_32x32x16_bf16 v[64:79], v[40:43], v[252:255], v[64:79]
  s_lshl_b32 s5, s60, 1
  s_add_u32 s5, s5, 0
  s_add_u32 s5, s5, 0
  s_and_b32 s5, s5, 7
  s_lshl_b32 s5, s5, 6
  s_mul_i32 s5, s5, s62
  s_lshl_b32 s7, s62, 4
  s_add_u32 m0, s65, 65536
  s_add_u32 s5, s5, s71
  buffer_load_dwordx4 v6, s[36:39], s5 offen lds
  s_add_u32 m0, s65, 66560
  s_add_u32 s5, s5, s7
  buffer_load_dwordx4 v6, s[36:39], s5 offen lds
  v_mfma_f32_32x32x16_bf16 v[80:95], v[44:47], v[252:255], v[80:95]
  s_add_u32 m0, s65, 67584
  s_add_u32 s5, s5, s7
  buffer_load_dwordx4 v6, s[36:39], s5 offen lds
  s_add_u32 m0, s65, 68608
  s_add_u32 s5, s5, s7
  buffer_load_dwordx4 v6, s[36:39], s5 offen lds
  s_waitcnt lgkmcnt(5)
  v_cmp_gt_u32 vcc, 32, v1
  v_xor_b32 v125, 0x8000, v125
  v_and_b32 v126, 0xffff, v125
  v_lshl_or_b32 v126, v126, 16, v126
  v_cndmask_b32 v16, 0, v126, vcc
  v_cndmask_b32 v17, 0, v125, vcc
  v_and_b32 v126, 0xffff0000, v125
  v_mov_b32 v18, 0
  v_mov_b32 v19, 0
  v_rcp_f32 v20, v126
  s_waitcnt lgkmcnt(0)
  v_mfma_f32_32x32x16_bf16 v[64:79], v[22:25], v[16:19], v[64:79]
  v_mfma_f32_32x32x16_bf16 v[80:95], v[26:29], v[16:19], v[80:95]
  s_lshl_b32 s5, s60, 1
  s_add_u32 s5, s5, 1
  s_add_u32 s5, s5, 0
  s_and_b32 s5, s5, 7
  s_lshl_b32 s5, s5, 6
  s_mul_i32 s5, s5, s62
  s_lshl_b32 s7, s62, 4
  s_add_u32 m0, s65, 69632
  s_add_u32 s5, s5, s71
  buffer_load_dwordx4 v6, s[36:39], s5 offen lds
  s_add_u32 m0, s65, 70656
  s_add_u32 s5, s5, s7
  buffer_load_dwordx4 v6, s[36:39], s5 offen lds
  s_add_u32 m0, s65, 71680
  s_add_u32 s5, s5, s7
  buffer_load_dwordx4 v6, s[36:39], s5 offen lds
  s_add_u32 m0, s65, 72704
  s_add_u32 s5, s5, s7
  buffer_load_dwordx4 v6, s[36:39], s5 offen lds
  s_waitcnt vmcnt(16)
  s_barrier
  v_mov_b32 v22, v60
  v_mov_b32 v23, v61
  v_mov_b32 v26, v58
  v_mov_b32 v27, v59
  v_xor_b32 v11, 64, v14
  v_max_f32 v64, 0, v64
  v_max_f32 v65, 0, v65
  v_max_f32 v66, 0, v66
  v_max_f32 v67, 0, v67
  v_max_f32 v68, 0, v68
  v_max_f32 v69, 0, v69
  v_max_f32 v70, 0, v70
  v_max_f32 v71, 0, v71
  v_mul_f32 v64, v64, v64
  v_mul_f32 v65, v65, v65
  v_mul_f32 v66, v66, v66
  v_mul_f32 v67, v67, v67
  v_mul_f32 v68, v68, v68
  v_mul_f32 v69, v69, v69
  v_mul_f32 v70, v70, v70
  v_mul_f32 v71, v71, v71
  s_add_u32 s86, s72, 0
  s_lshl_b32 s86, s86, 10
  s_add_u32 s86, s86, s77
  v_cvt_pk_bf16_f32 v48, v64, v65
  v_cvt_pk_bf16_f32 v49, v66, v67
  v_cvt_pk_bf16_f32 v50, v68, v69
  v_cvt_pk_bf16_f32 v51, v70, v71
  buffer_store_dwordx4 v[48:51], v15, s[40:43], s86 offen offset:0 sc1
  v_max_f32 v72, 0, v72
  v_max_f32 v73, 0, v73
  v_max_f32 v74, 0, v74
  v_max_f32 v75, 0, v75
  v_max_f32 v76, 0, v76
  v_max_f32 v77, 0, v77
  v_max_f32 v78, 0, v78
  v_max_f32 v79, 0, v79
  v_mul_f32 v72, v72, v72
  v_mul_f32 v73, v73, v73
  v_mul_f32 v74, v74, v74
  v_mul_f32 v75, v75, v75
  v_mul_f32 v76, v76, v76
  v_mul_f32 v77, v77, v77
  v_mul_f32 v78, v78, v78
  v_mul_f32 v79, v79, v79
  v_cvt_pk_bf16_f32 v52, v72, v73
  v_cvt_pk_bf16_f32 v53, v74, v75
  v_cvt_pk_bf16_f32 v54, v76, v77
  v_cvt_pk_bf16_f32 v55, v78, v79
  buffer_store_dwordx4 v[52:55], v15, s[40:43], s86 offen offset:1024 sc1
  v_max_f32 v80, 0, v80
  v_max_f32 v81, 0, v81
  v_max_f32 v82, 0, v82
  v_max_f32 v83, 0, v83
  v_max_f32 v84, 0, v84
  v_max_f32 v85, 0, v85
  v_max_f32 v86, 0, v86
  v_max_f32 v87, 0, v87
  v_mul_f32 v80, v80, v80
  v_mul_f32 v81, v81, v81
  v_mul_f32 v82, v82, v82
  v_mul_f32 v83, v83, v83
  v_mul_f32 v84, v84, v84
  v_mul_f32 v85, v85, v85
  v_mul_f32 v86, v86, v86
  v_mul_f32 v87, v87, v87
  s_add_u32 s86, s72, 2
  s_lshl_b32 s86, s86, 10
  s_add_u32 s86, s86, s77
  v_cvt_pk_bf16_f32 v48, v80, v81
  v_cvt_pk_bf16_f32 v49, v82, v83
  v_cvt_pk_bf16_f32 v50, v84, v85
  v_cvt_pk_bf16_f32 v51, v86, v87
  buffer_store_dwordx4 v[48:51], v15, s[40:43], s86 offen offset:0 sc1
  v_max_f32 v88, 0, v88
  v_max_f32 v89, 0, v89
  v_max_f32 v90, 0, v90
  v_max_f32 v91, 0, v91
  v_max_f32 v92, 0, v92
  v_max_f32 v93, 0, v93
  v_max_f32 v94, 0, v94
  v_max_f32 v95, 0, v95
  v_mul_f32 v88, v88, v88
  v_mul_f32 v89, v89, v89
  v_mul_f32 v90, v90, v90
  v_mul_f32 v91, v91, v91
  v_mul_f32 v92, v92, v92
  v_mul_f32 v93, v93, v93
  v_mul_f32 v94, v94, v94
  v_mul_f32 v95, v95, v95
  v_cvt_pk_bf16_f32 v52, v88, v89
  v_cvt_pk_bf16_f32 v53, v90, v91
  v_cvt_pk_bf16_f32 v54, v92, v93
  v_cvt_pk_bf16_f32 v55, v94, v95
  buffer_store_dwordx4 v[52:55], v15, s[40:43], s86 offen offset:1024 sc1
  s_setprio 2
  ds_read_b64_tr_b16 v[32:33], v14 offset:0
  ds_read_b64_tr_b16 v[34:35], v14 offset:512
  ds_read_b64_tr_b16 v[36:37], v11 offset:0
  ds_read_b64_tr_b16 v[38:39], v11 offset:512
  ds_read_b64_tr_b16 v[40:41], v14 offset:2048
  ds_read_b64_tr_b16 v[42:43], v14 offset:2560
  ds_read_b64_tr_b16 v[44:45], v11 offset:2048
  ds_read_b64_tr_b16 v[46:47], v11 offset:2560
  ds_read_b64_tr_b16 v[112:113], v14 offset:4096
  ds_read_b64_tr_b16 v[114:115], v14 offset:4608
  ds_read_b64_tr_b16 v[116:117], v11 offset:4096
  ds_read_b64_tr_b16 v[118:119], v11 offset:4608
  v_mfma_f32_32x32x16_bf16 v[96:111], v[22:25], v[16:19], 0
  v_mfma_f32_32x32x16_bf16 v[64:79], v[26:29], v[16:19], 0
  s_waitcnt lgkmcnt(10)
  v_mfma_f32_32x32x16_bf16 v[96:111], v[32:35], v[128:131], v[96:111]
  ds_read_b64_tr_b16 v[120:121], v14 offset:6144
  ds_read_b64_tr_b16 v[122:123], v14 offset:6656
  s_waitcnt lgkmcnt(10)
  v_mfma_f32_32x32x16_bf16 v[64:79], v[36:39], v[128:131], v[64:79]
  ds_read_b64_tr_b16 v[124:125], v11 offset:6144
  ds_read_b64_tr_b16 v[126:127], v11 offset:6656
  s_waitcnt lgkmcnt(10)
  v_mfma_f32_32x32x16_bf16 v[96:111], v[40:43], v[132:135], v[96:111]
  s_waitcnt vmcnt(12)
  v_mov_b32 v62, 256
  v_mov_b32 v21, 162304
  s_mov_b64 exec, 1
  ds_add_u32 v21, v62
  s_mov_b64 exec, -1
  ds_read_b64_tr_b16 v[32:33], v14 offset:8192
  ds_read_b64_tr_b16 v[34:35], v14 offset:8704
  v_lshrrev_b32 v12, 5, v1
  v_bfe_u32 v13, v1, 2, 2
  v_lshl_add_u32 v12, v12, 3, v13
  s_waitcnt lgkmcnt(11)
  v_mfma_f32_32x32x16_bf16 v[64:79], v[44:47], v[132:135], v[64:79]
  ds_read_b64_tr_b16 v[36:37], v11 offset:8192
  ds_read_b64_tr_b16 v[38:39], v11 offset:8704
  v_lshlrev_b32 v12, 6, v12
  v_bfe_u32 v13, v1, 4, 1
  v_lshl_add_u32 v12, v13, 5, v12
  s_waitcnt lgkmcnt(11)
  v_mfma_f32_32x32x16_bf16 v[96:111], v[112:115], v[136:139], v[96:111]
  ds_read_b64_tr_b16 v[40:41], v14 offset:10240
  ds_read_b64_tr_b16 v[42:43], v14 offset:10752
  v_and_b32 v13, 3, v1
  v_lshl_add_u32 v12, v13, 3, v12
  v_add_u32 v12, 0x10000, v12
  s_waitcnt lgkmcnt(11)
  v_mfma_f32_32x32x16_bf16 v[64:79], v[116:119], v[136:139], v[64:79]
  ds_read_b64_tr_b16 v[44:45], v11 offset:10240
  ds_read_b64_tr_b16 v[46:47], v11 offset:10752
  v_mov_b32 v22, v30
  v_mov_b32 v23, v31
  s_mov_b32 s44, s12
  s_waitcnt lgkmcnt(11)
  v_mfma_f32_32x32x16_bf16 v[96:111], v[120:123], v[140:143], v[96:111]
  ds_read_b64_tr_b16 v[112:113], v14 offset:12288
  ds_read_b64_tr_b16 v[114:115], v14 offset:12800
  s_mov_b32 s45, s13
  s_mov_b32 s46, 524288
  s_lshl_b32 s7, s60, 17
  s_waitcnt lgkmcnt(11)
  v_mfma_f32_32x32x16_bf16 v[64:79], v[124:127], v[140:143], v[64:79]
  ds_read_b64_tr_b16 v[116:117], v11 offset:12288
  ds_read_b64_tr_b16 v[118:119], v11 offset:12800
  s_lshl_b32 s87, s68, 7
  s_add_u32 s7, s7, s87
  s_lshl_b32 s64, s60, 13
  s_waitcnt lgkmcnt(10)
  v_mfma_f32_32x32x16_bf16 v[96:111], v[32:35], v[144:147], v[96:111]
  ds_read_b64_tr_b16 v[120:121], v14 offset:14336
  ds_read_b64_tr_b16 v[122:123], v14 offset:14848
  s_lshl_b32 s101, s66, 1
  s_add_u32 s101, s101, s67
  s_waitcnt lgkmcnt(10)
  v_mfma_f32_32x32x16_bf16 v[64:79], v[36:39], v[144:147], v[64:79]
  ds_read_b64_tr_b16 v[124:125], v11 offset:14336
  ds_read_b64_tr_b16 v[126:127], v11 offset:14848
  s_waitcnt lgkmcnt(10)
  v_mfma_f32_32x32x16_bf16 v[96:111], v[40:43], v[148:151], v[96:111]
  ds_read_b64_tr_b16 v[32:33], v14 offset:16384
  ds_read_b64_tr_b16 v[34:35], v14 offset:16896
  s_waitcnt lgkmcnt(10)
  v_mfma_f32_32x32x16_bf16 v[64:79], v[44:47], v[148:151], v[64:79]
  ds_read_b64_tr_b16 v[36:37], v11 offset:16384
  ds_read_b64_tr_b16 v[38:39], v11 offset:16896
  s_waitcnt lgkmcnt(10)
  v_mfma_f32_32x32x16_bf16 v[96:111], v[112:115], v[152:155], v[96:111]
  ds_read_b64_tr_b16 v[40:41], v14 offset:18432
  ds_read_b64_tr_b16 v[42:43], v14 offset:18944
  s_waitcnt lgkmcnt(10)
  v_mfma_f32_32x32x16_bf16 v[64:79], v[116:119], v[152:155], v[64:79]
  ds_read_b64_tr_b16 v[44:45], v11 offset:18432
  ds_read_b64_tr_b16 v[46:47], v11 offset:18944
  s_waitcnt lgkmcnt(10)
  v_mfma_f32_32x32x16_bf16 v[96:111], v[120:123], v[156:159], v[96:111]
  ds_read_b64_tr_b16 v[112:113], v14 offset:20480
  ds_read_b64_tr_b16 v[114:115], v14 offset:20992
  s_waitcnt lgkmcnt(10)
  v_mfma_f32_32x32x16_bf16 v[64:79], v[124:127], v[156:159], v[64:79]
  ds_read_b64_tr_b16 v[116:117], v11 offset:20480
  ds_read_b64_tr_b16 v[118:119], v11 offset:20992
  s_waitcnt lgkmcnt(10)
  v_mfma_f32_32x32x16_bf16 v[96:111], v[32:35], v[160:163], v[96:111]
  v_mov_b32 v21, 162304
  ds_read_b32 v62, v21
  ds_read_b64_tr_b16 v[120:121], v14 offset:22528
  ds_read_b64_tr_b16 v[122:123], v14 offset:23040
  s_waitcnt lgkmcnt(11)
  v_mfma_f32_32x32x16_bf16 v[64:79], v[36:39], v[160:163], v[64:79]
  ds_read_b64_tr_b16 v[124:125], v11 offset:22528
  ds_read_b64_tr_b16 v[126:127], v11 offset:23040
  s_waitcnt lgkmcnt(11)
  v_mfma_f32_32x32x16_bf16 v[96:111], v[40:43], v[164:167], v[96:111]
  ds_read_b64_tr_b16 v[32:33], v14 offset:24576
  ds_read_b64_tr_b16 v[34:35], v14 offset:25088
  s_waitcnt lgkmcnt(11)
  v_mfma_f32_32x32x16_bf16 v[64:79], v[44:47], v[164:167], v[64:79]
  ds_read_b64_tr_b16 v[36:37], v11 offset:24576
  ds_read_b64_tr_b16 v[38:39], v11 offset:25088
  s_waitcnt lgkmcnt(11)
  v_mfma_f32_32x32x16_bf16 v[96:111], v[112:115], v[168:171], v[96:111]
  ds_read_b64_tr_b16 v[40:41], v14 offset:26624
  ds_read_b64_tr_b16 v[42:43], v14 offset:27136
  s_waitcnt lgkmcnt(11)
  v_mfma_f32_32x32x16_bf16 v[64:79], v[116:119], v[168:171], v[64:79]
  ds_read_b64_tr_b16 v[44:45], v11 offset:26624
  ds_read_b64_tr_b16 v[46:47], v11 offset:27136
  s_waitcnt lgkmcnt(10)
  v_mfma_f32_32x32x16_bf16 v[96:111], v[120:123], v[172:175], v[96:111]
  ds_read_b64_tr_b16 v[112:113], v14 offset:28672
  ds_read_b64_tr_b16 v[114:115], v14 offset:29184
  s_waitcnt lgkmcnt(10)
  v_mfma_f32_32x32x16_bf16 v[64:79], v[124:127], v[172:175], v[64:79]
  ds_read_b64_tr_b16 v[116:117], v11 offset:28672
  ds_read_b64_tr_b16 v[118:119], v11 offset:29184
  s_waitcnt lgkmcnt(10)
  v_mfma_f32_32x32x16_bf16 v[96:111], v[32:35], v[176:179], v[96:111]
  v_readfirstlane_b32 s84, v62
  s_nop 0
  s_bfe_u32 s84, s84, 262152
  s_cmp_eq_u32 s84, 4
  s_cbranch_scc1 L_cok_1
L_cspin_2:
  ds_read_b32 v62, v21
  s_waitcnt lgkmcnt(0)
  v_readfirstlane_b32 s84, v62
  s_nop 0
  s_bfe_u32 s84, s84, 262152
  s_cmp_lg_u32 s84, 4
  s_cbranch_scc1 L_cspin_2
L_cok_1:
  ds_read_b64_tr_b16 v[120:121], v14 offset:30720
  ds_read_b64_tr_b16 v[122:123], v14 offset:31232
  s_waitcnt lgkmcnt(10)
  v_mfma_f32_32x32x16_bf16 v[64:79], v[36:39], v[176:179], v[64:79]
  ds_read_b64_tr_b16 v[124:125], v11 offset:30720
  ds_read_b64_tr_b16 v[126:127], v11 offset:31232
  s_waitcnt lgkmcnt(10)
  v_mfma_f32_32x32x16_bf16 v[96:111], v[40:43], v[180:183], v[96:111]
  s_waitcnt vmcnt(0)
  s_add_u32 s84, s59, 1
  v_mov_b32 v62, s84
  s_mov_b64 exec, 1
  buffer_store_dword v62, off, s[40:43], s80 sc1
  s_mov_b64 exec, -1
  ds_read_b64_tr_b16 v[32:33], v14 offset:32768
  ds_read_b64_tr_b16 v[34:35], v14 offset:33280
  s_waitcnt lgkmcnt(10)
  v_mfma_f32_32x32x16_bf16 v[64:79], v[44:47], v[180:183], v[64:79]
  ds_read_b64_tr_b16 v[36:37], v11 offset:32768
  ds_read_b64_tr_b16 v[38:39], v11 offset:33280
  s_waitcnt lgkmcnt(10)
  v_mfma_f32_32x32x16_bf16 v[96:111], v[112:115], v[184:187], v[96:111]
  ds_read_b64_tr_b16 v[40:41], v14 offset:34816
  ds_read_b64_tr_b16 v[42:43], v14 offset:35328
  s_waitcnt lgkmcnt(10)
  v_mfma_f32_32x32x16_bf16 v[64:79], v[116:119], v[184:187], v[64:79]
  ds_read_b64_tr_b16 v[44:45], v11 offset:34816
  ds_read_b64_tr_b16 v[46:47], v11 offset:35328
  s_waitcnt lgkmcnt(10)
  v_mfma_f32_32x32x16_bf16 v[96:111], v[120:123], v[188:191], v[96:111]
  ds_read_b64_tr_b16 v[112:113], v14 offset:36864
  ds_read_b64_tr_b16 v[114:115], v14 offset:37376
  s_waitcnt lgkmcnt(10)
  v_mfma_f32_32x32x16_bf16 v[64:79], v[124:127], v[188:191], v[64:79]
  ds_read_b64_tr_b16 v[116:117], v11 offset:36864
  ds_read_b64_tr_b16 v[118:119], v11 offset:37376
  s_waitcnt lgkmcnt(10)
  v_mfma_f32_32x32x16_bf16 v[96:111], v[32:35], v[192:195], v[96:111]
  v_mov_b32 v62, 1
  v_mov_b32 v21, 162304
  s_mov_b64 exec, 1
  ds_add_u32 v21, v62
  s_mov_b64 exec, -1
  ds_read_b64_tr_b16 v[120:121], v14 offset:38912
  ds_read_b64_tr_b16 v[122:123], v14 offset:39424
  s_waitcnt lgkmcnt(11)
  v_mfma_f32_32x32x16_bf16 v[64:79], v[36:39], v[192:195], v[64:79]
  ds_read_b64_tr_b16 v[124:125], v11 offset:38912
  ds_read_b64_tr_b16 v[126:127], v11 offset:39424
  s_waitcnt lgkmcnt(11)
  v_mfma_f32_32x32x16_bf16 v[96:111], v[40:43], v[196:199], v[96:111]
  ds_read_b64_tr_b16 v[32:33], v14 offset:40960
  ds_read_b64_tr_b16 v[34:35], v14 offset:41472
  s_waitcnt lgkmcnt(11)
  v_mfma_f32_32x32x16_bf16 v[64:79], v[44:47], v[196:199], v[64:79]
  ds_read_b64_tr_b16 v[36:37], v11 offset:40960
  ds_read_b64_tr_b16 v[38:39], v11 offset:41472
  s_waitcnt lgkmcnt(11)
  v_mfma_f32_32x32x16_bf16 v[96:111], v[112:115], v[200:203], v[96:111]
  v_mov_b32 v21, 162304
  ds_read_b32 v62, v21
  ds_read_b64_tr_b16 v[40:41], v14 offset:43008
  ds_read_b64_tr_b16 v[42:43], v14 offset:43520
  s_waitcnt lgkmcnt(12)
  v_mfma_f32_32x32x16_bf16 v[64:79], v[116:119], v[200:203], v[64:79]
  ds_read_b64_tr_b16 v[44:45], v11 offset:43008
  ds_read_b64_tr_b16 v[46:47], v11 offset:43520
  s_waitcnt lgkmcnt(11)
  v_mfma_f32_32x32x16_bf16 v[96:111], v[120:123], v[204:207], v[96:111]
  ds_read_b64_tr_b16 v[112:113], v14 offset:45056
  ds_read_b64_tr_b16 v[114:115], v14 offset:45568
  s_waitcnt lgkmcnt(11)
  v_mfma_f32_32x32x16_bf16 v[64:79], v[124:127], v[204:207], v[64:79]
  ds_read_b64_tr_b16 v[116:117], v11 offset:45056
  ds_read_b64_tr_b16 v[118:119], v11 offset:45568
  s_waitcnt lgkmcnt(11)
  v_mfma_f32_32x32x16_bf16 v[96:111], v[32:35], v[208:211], v[96:111]
  ds_read_b64_tr_b16 v[120:121], v14 offset:47104
  ds_read_b64_tr_b16 v[122:123], v14 offset:47616
  s_waitcnt lgkmcnt(11)
  v_mfma_f32_32x32x16_bf16 v[64:79], v[36:39], v[208:211], v[64:79]
  ds_read_b64_tr_b16 v[124:125], v11 offset:47104
  ds_read_b64_tr_b16 v[126:127], v11 offset:47616
  s_waitcnt lgkmcnt(10)
  v_mfma_f32_32x32x16_bf16 v[96:111], v[40:43], v[212:215], v[96:111]
  v_readfirstlane_b32 s84, v62
  s_nop 0
  s_bfe_u32 s84, s84, 262144
  s_cmp_eq_u32 s84, 4
  s_cbranch_scc1 L_cok_3
L_cspin_4:
  ds_read_b32 v62, v21
  s_waitcnt lgkmcnt(0)
  v_readfirstlane_b32 s84, v62
  s_nop 0
  s_bfe_u32 s84, s84, 262144
  s_cmp_lg_u32 s84, 4
  s_cbranch_scc1 L_cspin_4
L_cok_3:
  ds_read_b64_tr_b16 v[32:33], v14 offset:49152
  ds_read_b64_tr_b16 v[34:35], v14 offset:49664
  s_add_u32 m0, s64, 0
  s_nop 0
  buffer_load_dwordx4 v7, s[44:47], s7 offen lds
  s_waitcnt lgkmcnt(10)
  v_mfma_f32_32x32x16_bf16 v[64:79], v[44:47], v[212:215], v[64:79]
  ds_read_b64_tr_b16 v[36:37], v11 offset:49152
  ds_read_b64_tr_b16 v[38:39], v11 offset:49664
  s_add_u32 m0, s64, 1024
  s_add_u32 s7, s7, 8192
  buffer_load_dwordx4 v7, s[44:47], s7 offen lds
  s_waitcnt lgkmcnt(10)
  v_mfma_f32_32x32x16_bf16 v[96:111], v[112:115], v[216:219], v[96:111]
  ds_read_b64_tr_b16 v[40:41], v14 offset:51200
  ds_read_b64_tr_b16 v[42:43], v14 offset:51712
  s_add_u32 m0, s64, 2048
  s_add_u32 s7, s7, 8192
  buffer_load_dwordx4 v7, s[44:47], s7 offen lds
  s_waitcnt lgkmcnt(10)
  v_mfma_f32_32x32x16_bf16 v[64:79], v[116:119], v[216:219], v[64:79]
  ds_read_b64_tr_b16 v[44:45], v11 offset:51200
  ds_read_b64_tr_b16 v[46:47], v11 offset:51712
  s_add_u32 m0, s64, 3072
  s_add_u32 s7, s7, 8192
  buffer_load_dwordx4 v7, s[44:47], s7 offen lds
  s_waitcnt lgkmcnt(10)
  v_mfma_f32_32x32x16_bf16 v[96:111], v[120:123], v[220:223], v[96:111]
  v_mov_b32 v62, 65536
  v_mov_b32 v21, 162304
  s_mov_b64 exec, 1
  ds_add_u32 v21, v62
  s_mov_b64 exec, -1
  ds_read_b64_tr_b16 v[112:113], v14 offset:53248
  ds_read_b64_tr_b16 v[114:115], v14 offset:53760
  s_add_u32 m0, s64, 4096
  s_add_u32 s7, s7, 8192
  buffer_load_dwordx4 v7, s[44:47], s7 offen lds
  s_waitcnt lgkmcnt(11)
  v_mfma_f32_32x32x16_bf16 v[64:79], v[124:127], v[220:223], v[64:79]
  ds_read_b64_tr_b16 v[116:117], v11 offset:53248
  ds_read_b64_tr_b16 v[118:119], v11 offset:53760
  s_add_u32 m0, s64, 5120
  s_add_u32 s7, s7, 8192
  buffer_load_dwordx4 v7, s[44:47], s7 offen lds
  s_waitcnt lgkmcnt(11)
  v_mfma_f32_32x32x16_bf16 v[96:111], v[32:35], v[224:227], v[96:111]
  ds_read_b64_tr_b16 v[120:121], v14 offset:55296
  ds_read_b64_tr_b16 v[122:123], v14 offset:55808
  s_add_u32 m0, s64, 6144
  s_add_u32 s7, s7, 8192
  buffer_load_dwordx4 v7, s[44:47], s7 offen lds
  s_waitcnt lgkmcnt(11)
  v_mfma_f32_32x32x16_bf16 v[64:79], v[36:39], v[224:227], v[64:79]
  ds_read_b64_tr_b16 v[124:125], v11 offset:55296
  ds_read_b64_tr_b16 v[126:127], v11 offset:55808
  s_add_u32 m0, s64, 7168
  s_add_u32 s7, s7, 8192
  buffer_load_dwordx4 v7, s[44:47], s7 offen lds
  s_waitcnt lgkmcnt(11)
  v_mfma_f32_32x32x16_bf16 v[96:111], v[40:43], v[228:231], v[96:111]
  v_mov_b32 v21, 162304
  ds_read_b32 v62, v21
  ds_read_b64_tr_b16 v[32:33], v14 offset:57344
  ds_read_b64_tr_b16 v[34:35], v14 offset:57856
  s_waitcnt lgkmcnt(12)
  v_mfma_f32_32x32x16_bf16 v[64:79], v[44:47], v[228:231], v[64:79]
  ds_read_b64_tr_b16 v[36:37], v11 offset:57344
  ds_read_b64_tr_b16 v[38:39], v11 offset:57856
  s_waitcnt lgkmcnt(11)
  v_mfma_f32_32x32x16_bf16 v[96:111], v[112:115], v[232:235], v[96:111]
  ds_read_b64_tr_b16 v[40:41], v14 offset:59392
  ds_read_b64_tr_b16 v[42:43], v14 offset:59904
  s_waitcnt lgkmcnt(11)
  v_mfma_f32_32x32x16_bf16 v[64:79], v[116:119], v[232:235], v[64:79]
  ds_read_b64_tr_b16 v[44:45], v11 offset:59392
  ds_read_b64_tr_b16 v[46:47], v11 offset:59904
  s_waitcnt lgkmcnt(11)
  v_mfma_f32_32x32x16_bf16 v[96:111], v[120:123], v[236:239], v[96:111]
  ds_read_b64_tr_b16 v[112:113], v14 offset:61440
  ds_read_b64_tr_b16 v[114:115], v14 offset:61952
  s_waitcnt lgkmcnt(11)
  v_mfma_f32_32x32x16_bf16 v[64:79], v[124:127], v[236:239], v[64:79]
  ds_read_b64_tr_b16 v[116:117], v11 offset:61440
  ds_read_b64_tr_b16 v[118:119], v11 offset:61952
  s_waitcnt lgkmcnt(10)
  v_mfma_f32_32x32x16_bf16 v[96:111], v[32:35], v[240:243], v[96:111]
  v_readfirstlane_b32 s84, v62
  s_nop 0
  s_bfe_u32 s84, s84, 262160
  s_cmp_eq_u32 s84, 4
  s_cbranch_scc1 L_cok_5
L_cspin_6:
  ds_read_b32 v62, v21
  s_waitcnt lgkmcnt(0)
  v_readfirstlane_b32 s84, v62
  s_nop 0
  s_bfe_u32 s84, s84, 262160
  s_cmp_lg_u32 s84, 4
  s_cbranch_scc1 L_cspin_6
L_cok_5:
  ds_read_b64_tr_b16 v[120:121], v14 offset:63488
  ds_read_b64_tr_b16 v[122:123], v14 offset:64000
  s_waitcnt lgkmcnt(10)
  v_mfma_f32_32x32x16_bf16 v[64:79], v[36:39], v[240:243], v[64:79]
  ds_read_b64_tr_b16 v[124:125], v11 offset:63488
  ds_read_b64_tr_b16 v[126:127], v11 offset:64000
  s_waitcnt lgkmcnt(10)
  v_mfma_f32_32x32x16_bf16 v[96:111], v[40:43], v[244:247], v[96:111]
  ds_read_b64_tr_b16 v[32:33], v12 offset:0
  ds_read_b64_tr_b16 v[34:35], v12 offset:256
  s_waitcnt lgkmcnt(10)
  v_mfma_f32_32x32x16_bf16 v[64:79], v[44:47], v[244:247], v[64:79]
  ds_read_b64_tr_b16 v[36:37], v12 offset:1024
  ds_read_b64_tr_b16 v[38:39], v12 offset:1280
  s_waitcnt lgkmcnt(10)
  v_mfma_f32_32x32x16_bf16 v[96:111], v[112:115], v[248:251], v[96:111]
  ds_read_b64_tr_b16 v[40:41], v12 offset:2048
  ds_read_b64_tr_b16 v[42:43], v12 offset:2304
  s_waitcnt lgkmcnt(10)
  v_mfma_f32_32x32x16_bf16 v[64:79], v[116:119], v[248:251], v[64:79]
  ds_read_b64_tr_b16 v[44:45], v12 offset:3072
  ds_read_b64_tr_b16 v[46:47], v12 offset:3328
  s_waitcnt lgkmcnt(10)
  v_mfma_f32_32x32x16_bf16 v[96:111], v[120:123], v[252:255], v[96:111]
  ds_read_b64_tr_b16 v[112:113], v12 offset:4096
  ds_read_b64_tr_b16 v[114:115], v12 offset:4352
  s_waitcnt lgkmcnt(10)
  v_mfma_f32_32x32x16_bf16 v[64:79], v[124:127], v[252:255], v[64:79]
  ds_read_b64_tr_b16 v[116:117], v12 offset:5120
  ds_read_b64_tr_b16 v[118:119], v12 offset:5376
  v_mfma_f32_32x32x16_bf16 v[80:95], v[22:25], v[16:19], 0
  s_waitcnt lgkmcnt(10)
  v_mfma_f32_32x32x16_bf16 v[80:95], v[32:35], v[128:131], v[80:95]
  v_mov_b32 v62, 1048576
  v_mov_b32 v21, 162304
  s_mov_b64 exec, 1
  ds_add_u32 v21, v62
  s_mov_b64 exec, -1
  v_max_f32 v96, 0, v96
  v_max_f32 v97, 0, v97
  v_max_f32 v98, 0, v98
  v_max_f32 v99, 0, v99
  v_max_f32 v100, 0, v100
  v_max_f32 v101, 0, v101
  v_max_f32 v102, 0, v102
  v_max_f32 v103, 0, v103
  v_mul_f32 v96, v96, v96
  v_mul_f32 v97, v97, v97
  v_mul_f32 v98, v98, v98
  v_mul_f32 v99, v99, v99
  v_mul_f32 v100, v100, v100
  v_mul_f32 v101, v101, v101
  v_mul_f32 v102, v102, v102
  v_mul_f32 v103, v103, v103
  s_add_u32 s86, s81, 0
  s_lshl_b32 s86, s86, 10
  s_add_u32 s86, s86, s77
  v_cvt_pk_bf16_f32 v48, v96, v97
  v_cvt_pk_bf16_f32 v49, v98, v99
  v_cvt_pk_bf16_f32 v50, v100, v101
  v_cvt_pk_bf16_f32 v51, v102, v103
  buffer_store_dwordx4 v[48:51], v15, s[40:43], s86 offen offset:0 sc1
  v_max_f32 v104, 0, v104
  v_max_f32 v105, 0, v105
  v_max_f32 v106, 0, v106
  v_max_f32 v107, 0, v107
  v_max_f32 v108, 0, v108
  v_max_f32 v109, 0, v109
  v_max_f32 v110, 0, v110
  v_max_f32 v111, 0, v111
  v_mul_f32 v104, v104, v104
  v_mul_f32 v105, v105, v105
  v_mul_f32 v106, v106, v106
  v_mul_f32 v107, v107, v107
  v_mul_f32 v108, v108, v108
  v_mul_f32 v109, v109, v109
  v_mul_f32 v110, v110, v110
  v_mul_f32 v111, v111, v111
  v_cvt_pk_bf16_f32 v52, v104, v105
  v_cvt_pk_bf16_f32 v53, v106, v107
  v_cvt_pk_bf16_f32 v54, v108, v109
  v_cvt_pk_bf16_f32 v55, v110, v111
  buffer_store_dwordx4 v[52:55], v15, s[40:43], s86 offen offset:1024 sc1
  v_max_f32 v64, 0, v64
  v_max_f32 v65, 0, v65
  v_max_f32 v66, 0, v66
  v_max_f32 v67, 0, v67
  v_max_f32 v68, 0, v68
  v_max_f32 v69, 0, v69
  v_max_f32 v70, 0, v70
  v_max_f32 v71, 0, v71
  v_mul_f32 v64, v64, v64
  v_mul_f32 v65, v65, v65
  v_mul_f32 v66, v66, v66
  v_mul_f32 v67, v67, v67
  v_mul_f32 v68, v68, v68
  v_mul_f32 v69, v69, v69
  v_mul_f32 v70, v70, v70
  v_mul_f32 v71, v71, v71
  s_add_u32 s86, s81, 2
  s_lshl_b32 s86, s86, 10
  s_add_u32 s86, s86, s77
  v_cvt_pk_bf16_f32 v48, v64, v65
  v_cvt_pk_bf16_f32 v49, v66, v67
  v_cvt_pk_bf16_f32 v50, v68, v69
  v_cvt_pk_bf16_f32 v51, v70, v71
  buffer_store_dwordx4 v[48:51], v15, s[40:43], s86 offen offset:0 sc1
  v_max_f32 v72, 0, v72
  v_max_f32 v73, 0, v73
  v_max_f32 v74, 0, v74
  v_max_f32 v75, 0, v75
  v_max_f32 v76, 0, v76
  v_max_f32 v77, 0, v77
  v_max_f32 v78, 0, v78
  v_max_f32 v79, 0, v79
  v_mul_f32 v72, v72, v72
  v_mul_f32 v73, v73, v73
  v_mul_f32 v74, v74, v74
  v_mul_f32 v75, v75, v75
  v_mul_f32 v76, v76, v76
  v_mul_f32 v77, v77, v77
  v_mul_f32 v78, v78, v78
  v_mul_f32 v79, v79, v79
  v_cvt_pk_bf16_f32 v52, v72, v73
  v_cvt_pk_bf16_f32 v53, v74, v75
  v_cvt_pk_bf16_f32 v54, v76, v77
  v_cvt_pk_bf16_f32 v55, v78, v79
  buffer_store_dwordx4 v[52:55], v15, s[40:43], s86 offen offset:1024 sc1
  ds_read_b64_tr_b16 v[120:121], v12 offset:6144
  ds_read_b64_tr_b16 v[122:123], v12 offset:6400
  s_waitcnt lgkmcnt(11)
  v_mfma_f32_32x32x16_bf16 v[80:95], v[36:39], v[132:135], v[80:95]
  ds_read_b64_tr_b16 v[124:125], v12 offset:7168
  ds_read_b64_tr_b16 v[126:127], v12 offset:7424
  s_waitcnt lgkmcnt(11)
  v_mfma_f32_32x32x16_bf16 v[80:95], v[40:43], v[136:139], v[80:95]
  ds_read_b64_tr_b16 v[32:33], v12 offset:8192
  ds_read_b64_tr_b16 v[34:35], v12 offset:8448
  s_waitcnt lgkmcnt(11)
  v_mfma_f32_32x32x16_bf16 v[80:95], v[44:47], v[140:143], v[80:95]
  ds_read_b64_tr_b16 v[36:37], v12 offset:9216
  ds_read_b64_tr_b16 v[38:39], v12 offset:9472
  s_waitcnt lgkmcnt(11)
  v_mfma_f32_32x32x16_bf16 v[80:95], v[112:115], v[144:147], v[80:95]
  ds_read_b64_tr_b16 v[40:41], v12 offset:10240
  ds_read_b64_tr_b16 v[42:43], v12 offset:10496
  s_waitcnt lgkmcnt(11)
  v_mfma_f32_32x32x16_bf16 v[80:95], v[116:119], v[148:151], v[80:95]
  ds_read_b64_tr_b16 v[44:45], v12 offset:11264
  ds_read_b64_tr_b16 v[46:47], v12 offset:11520
  s_waitcnt lgkmcnt(10)
  v_mfma_f32_32x32x16_bf16 v[80:95], v[120:123], v[152:155], v[80:95]
  v_mov_b32 v21, 162304
  ds_read_b32 v62, v21
  ds_read_b64_tr_b16 v[112:113], v12 offset:12288
  ds_read_b64_tr_b16 v[114:115], v12 offset:12544
  s_waitcnt lgkmcnt(11)
  v_mfma_f32_32x32x16_bf16 v[80:95], v[124:127], v[156:159], v[80:95]
  ds_read_b64_tr_b16 v[116:117], v12 offset:13312
  ds_read_b64_tr_b16 v[118:119], v12 offset:13568
  s_waitcnt lgkmcnt(11)
  v_mfma_f32_32x32x16_bf16 v[80:95], v[32:35], v[160:163], v[80:95]
  ds_read_b64_tr_b16 v[120:121], v12 offset:14336
  ds_read_b64_tr_b16 v[122:123], v12 offset:14592
  s_waitcnt lgkmcnt(11)
  v_mfma_f32_32x32x16_bf16 v[80:95], v[36:39], v[164:167], v[80:95]
  ds_read_b64_tr_b16 v[124:125], v12 offset:15360
  ds_read_b64_tr_b16 v[126:127], v12 offset:15616
  s_waitcnt lgkmcnt(11)
  v_mfma_f32_32x32x16_bf16 v[80:95], v[40:43], v[168:171], v[80:95]
  ds_read_b64_tr_b16 v[32:33], v12 offset:16384
  ds_read_b64_tr_b16 v[34:35], v12 offset:16640
  s_waitcnt lgkmcnt(11)
  v_mfma_f32_32x32x16_bf16 v[80:95], v[44:47], v[172:175], v[80:95]
  ds_read_b64_tr_b16 v[36:37], v12 offset:17408
  ds_read_b64_tr_b16 v[38:39], v12 offset:17664
  s_waitcnt lgkmcnt(10)
  v_mfma_f32_32x32x16_bf16 v[80:95], v[112:115], v[176:179], v[80:95]
  v_readfirstlane_b32 s84, v62
  s_nop 0
  s_bfe_u32 s84, s84, 262164
  s_cmp_eq_u32 s84, 4
  s_cbranch_scc1 L_cok_7
L_cspin_8:
  ds_read_b32 v62, v21
  s_waitcnt lgkmcnt(0)
  v_readfirstlane_b32 s84, v62
  s_nop 0
  s_bfe_u32 s84, s84, 262164
  s_cmp_lg_u32 s84, 4
  s_cbranch_scc1 L_cspin_8
L_cok_7:
  ds_read_b64_tr_b16 v[40:41], v12 offset:18432
  ds_read_b64_tr_b16 v[42:43], v12 offset:18688
  s_add_u32 m0, s64, 32768
  s_add_u32 s7, s7, 8192
  buffer_load_dwordx4 v7, s[44:47], s7 offen lds
  s_waitcnt lgkmcnt(10)
  v_mfma_f32_32x32x16_bf16 v[80:95], v[116:119], v[180:183], v[80:95]
  ds_read_b64_tr_b16 v[44:45], v12 offset:19456
  ds_read_b64_tr_b16 v[46:47], v12 offset:19712
  s_add_u32 m0, s64, 33792
  s_add_u32 s7, s7, 8192
  buffer_load_dwordx4 v7, s[44:47], s7 offen lds
  s_waitcnt lgkmcnt(10)
  v_mfma_f32_32x32x16_bf16 v[80:95], v[120:123], v[184:187], v[80:95]
  ds_read_b64_tr_b16 v[112:113], v12 offset:20480
  ds_read_b64_tr_b16 v[114:115], v12 offset:20736
  s_add_u32 m0, s64, 34816
  s_add_u32 s7, s7, 8192
  buffer_load_dwordx4 v7, s[44:47], s7 offen lds
  s_waitcnt lgkmcnt(10)
  v_mfma_f32_32x32x16_bf16 v[80:95], v[124:127], v[188:191], v[80:95]
  ds_read_b64_tr_b16 v[116:117], v12 offset:21504
  ds_read_b64_tr_b16 v[118:119], v12 offset:21760
  s_add_u32 m0, s64, 35840
  s_add_u32 s7, s7, 8192
  buffer_load_dwordx4 v7, s[44:47], s7 offen lds
  s_waitcnt lgkmcnt(10)
  v_mfma_f32_32x32x16_bf16 v[80:95], v[32:35], v[192:195], v[80:95]
  ds_read_b64_tr_b16 v[120:121], v12 offset:22528
  ds_read_b64_tr_b16 v[122:123], v12 offset:22784
  s_add_u32 m0, s64, 36864
  s_add_u32 s7, s7, 8192
  buffer_load_dwordx4 v7, s[44:47], s7 offen lds
  s_waitcnt lgkmcnt(10)
  v_mfma_f32_32x32x16_bf16 v[80:95], v[36:39], v[196:199], v[80:95]
  ds_read_b64_tr_b16 v[124:125], v12 offset:23552
  ds_read_b64_tr_b16 v[126:127], v12 offset:23808
  s_add_u32 m0, s64, 37888
  s_add_u32 s7, s7, 8192
  buffer_load_dwordx4 v7, s[44:47], s7 offen lds
  s_waitcnt lgkmcnt(10)
  v_mfma_f32_32x32x16_bf16 v[80:95], v[40:43], v[200:203], v[80:95]
  ds_read_b64_tr_b16 v[32:33], v12 offset:24576
  ds_read_b64_tr_b16 v[34:35], v12 offset:24832
  s_add_u32 m0, s64, 38912
  s_add_u32 s7, s7, 8192
  buffer_load_dwordx4 v7, s[44:47], s7 offen lds
  s_waitcnt lgkmcnt(10)
  v_mfma_f32_32x32x16_bf16 v[80:95], v[44:47], v[204:207], v[80:95]
  ds_read_b64_tr_b16 v[36:37], v12 offset:25600
  ds_read_b64_tr_b16 v[38:39], v12 offset:25856
  s_add_u32 m0, s64, 39936
  s_add_u32 s7, s7, 8192
  buffer_load_dwordx4 v7, s[44:47], s7 offen lds
  s_waitcnt lgkmcnt(10)
  v_mfma_f32_32x32x16_bf16 v[80:95], v[112:115], v[208:211], v[80:95]
  ds_read_b64_tr_b16 v[40:41], v12 offset:26624
  ds_read_b64_tr_b16 v[42:43], v12 offset:26880
  s_waitcnt lgkmcnt(10)
  v_mfma_f32_32x32x16_bf16 v[80:95], v[116:119], v[212:215], v[80:95]
  ds_read_b64_tr_b16 v[44:45], v12 offset:27648
  ds_read_b64_tr_b16 v[46:47], v12 offset:27904
  s_waitcnt lgkmcnt(10)
  v_mfma_f32_32x32x16_bf16 v[80:95], v[120:123], v[216:219], v[80:95]
  ds_read_b64_tr_b16 v[112:113], v12 offset:28672
  ds_read_b64_tr_b16 v[114:115], v12 offset:28928
  s_waitcnt lgkmcnt(10)
  v_mfma_f32_32x32x16_bf16 v[80:95], v[124:127], v[220:223], v[80:95]
  ds_read_b64_tr_b16 v[116:117], v12 offset:29696
  ds_read_b64_tr_b16 v[118:119], v12 offset:29952
  s_waitcnt lgkmcnt(10)
  v_mfma_f32_32x32x16_bf16 v[80:95], v[32:35], v[224:227], v[80:95]
  ds_read_b64_tr_b16 v[120:121], v12 offset:30720
  ds_read_b64_tr_b16 v[122:123], v12 offset:30976
  s_waitcnt lgkmcnt(10)
  v_mfma_f32_32x32x16_bf16 v[80:95], v[36:39], v[228:231], v[80:95]
  ds_read_b64_tr_b16 v[124:125], v12 offset:31744
  ds_read_b64_tr_b16 v[126:127], v12 offset:32000
  s_waitcnt lgkmcnt(10)
  v_mfma_f32_32x32x16_bf16 v[80:95], v[40:43], v[232:235], v[80:95]
  s_waitcnt lgkmcnt(8)
  v_mfma_f32_32x32x16_bf16 v[80:95], v[44:47], v[236:239], v[80:95]
  s_waitcnt lgkmcnt(6)
  v_mfma_f32_32x32x16_bf16 v[80:95], v[112:115], v[240:243], v[80:95]
  s_waitcnt vmcnt(8)
  s_add_u32 s84, s59, 2
  v_mov_b32 v62, s84
  s_mov_b64 exec, 1
  buffer_store_dword v62, off, s[40:43], s80 sc1
  s_mov_b64 exec, -1
  s_waitcnt lgkmcnt(4)
  v_mfma_f32_32x32x16_bf16 v[80:95], v[116:119], v[244:247], v[80:95]
  s_waitcnt lgkmcnt(2)
  v_mfma_f32_32x32x16_bf16 v[80:95], v[120:123], v[248:251], v[80:95]
  s_waitcnt lgkmcnt(0)
  v_mfma_f32_32x32x16_bf16 v[80:95], v[124:127], v[252:255], v[80:95]
  s_setprio 0
  s_nop 10
  v_max_f32 v80, 0, v80
  v_max_f32 v81, 0, v81
  v_max_f32 v82, 0, v82
  v_max_f32 v83, 0, v83
  v_max_f32 v84, 0, v84
  v_max_f32 v85, 0, v85
  v_max_f32 v86, 0, v86
  v_max_f32 v87, 0, v87
  v_mul_f32 v80, v80, v80
  v_mul_f32 v81, v81, v81
  v_mul_f32 v82, v82, v82
  v_mul_f32 v83, v83, v83
  v_mul_f32 v84, v84, v84
  v_mul_f32 v85, v85, v85
  v_mul_f32 v86, v86, v86
  v_mul_f32 v87, v87, v87
  s_add_u32 s86, s82, 0
  s_lshl_b32 s86, s86, 10
  s_add_u32 s86, s86, s77
  v_cvt_pk_bf16_f32 v48, v80, v81
  v_cvt_pk_bf16_f32 v49, v82, v83
  v_cvt_pk_bf16_f32 v50, v84, v85
  v_cvt_pk_bf16_f32 v51, v86, v87
  buffer_store_dwordx4 v[48:51], v15, s[40:43], s86 offen offset:0 sc1
  v_max_f32 v88, 0, v88
  v_max_f32 v89, 0, v89
  v_max_f32 v90, 0, v90
  v_max_f32 v91, 0, v91
  v_max_f32 v92, 0, v92
  v_max_f32 v93, 0, v93
  v_max_f32 v94, 0, v94
  v_max_f32 v95, 0, v95
  v_mul_f32 v88, v88, v88
  v_mul_f32 v89, v89, v89
  v_mul_f32 v90, v90, v90
  v_mul_f32 v91, v91, v91
  v_mul_f32 v92, v92, v92
  v_mul_f32 v93, v93, v93
  v_mul_f32 v94, v94, v94
  v_mul_f32 v95, v95, v95
  v_cvt_pk_bf16_f32 v52, v88, v89
  v_cvt_pk_bf16_f32 v53, v90, v91
  v_cvt_pk_bf16_f32 v54, v92, v93
  v_cvt_pk_bf16_f32 v55, v94, v95
  buffer_store_dwordx4 v[52:55], v15, s[40:43], s86 offen offset:1024 sc1
  v_mov_b32 v62, 16
  v_mov_b32 v21, 162304
  s_mov_b64 exec, 1
  ds_add_u32 v21, v62
  s_mov_b64 exec, -1
  v_bfe_u32 v22, v1, 2, 2
  v_lshrrev_b32 v23, 5, v1
  v_lshl_add_u32 v23, v23, 4, v22
  v_lshlrev_b32 v23, 7, v23
  v_lshrrev_b32 v22, 1, v22
  v_lshl_add_u32 v23, v22, 6, v23
  v_bfe_u32 v22, v1, 4, 1
  v_lshl_add_u32 v23, v22, 5, v23
  v_and_b32 v22, 3, v1
  v_lshl_add_u32 v23, v22, 3, v23
  v_add_u32 v4, s64, v23
  v_xor_b32 v5, 64, v4
  v_add_u32 v3, 147456, v15
  s_lshl_b32 s84, s66, 1
  s_add_u32 s84, s84, s67
  s_mul_i32 s63, s84, 294912
  s_mul_i32 s84, s60, 8192
  s_add_u32 s63, s63, s84
  s_lshl_b32 s90, s66, 1
  s_add_u32 s90, s90, s67
  s_lshl_b32 s90, s90, 10
  s_lshl_b32 s85, s60, 7
  s_add_u32 s90, s90, s85
  s_add_u32 s90, s90, 10698752
  s_waitcnt vmcnt(0)
  s_add_u32 s84, s59, 3
  v_mov_b32 v62, s84
  s_mov_b64 exec, 1
  buffer_store_dword v62, off, s[40:43], s80 sc1
  s_mov_b64 exec, -1
  s_branch L_p3s
L_ffn_h1:
  s_mov_b32 s36, s16
  s_mov_b32 s37, s17
  s_mov_b32 s38, 1835008
  s_mov_b32 s39, 0x20000
  s_movk_i32 s62, 3584
  s_movk_i32 s3, 14336
  v_xor_b32 v11, v8, v9
  v_lshlrev_b32 v11, 4, v11
  v_lshl_add_u32 v2, v10, 10, v11
  v_xor_b32 v3, 64, v2
  v_add_u32 v3, 8192, v3
  s_lshl_b32 s65, s56, 12
  s_lshl_b32 s63, s57, 3
  s_add_u32 s63, s63, s56
  s_lshl_b32 s63, s63, 14
  v_and_b32 v12, 15, v1
  v_lshlrev_b32 v13, 2, v9
  v_xor_b32 v12, v12, v13
  s_mul_i32 s88, s58, 448
  s_and_b32 s89, s58, 1
  s_lshl_b32 s89, s89, 6
  s_add_u32 s69, s88, s89
  s_sub_u32 s69, s69, 3584
  v_lshlrev_b32 v12, 4, v12
  v_mad_u32_u24 v4, v9, s62, v12
  s_mul_i32 s64, s56, 28672
  s_add_u32 s64, s64, s69
  s_mov_b32 s87, 10731520
  s_load_dword s73, s[28:29], s87
  s_mov_b32 s74, 0x3f803f80
  s_mov_b32 s75, 0x00003f80
  s_mov_b32 s76, 0x3f800000
  s_mov_b32 s40, s28
  s_mov_b32 s41, s29
  s_mov_b32 s42, 14155776
  s_mov_b32 s43, 0x20000
  v_and_b32 v14, 3, v1
  v_and_b32 v22, 1, v9
  v_lshlrev_b32 v26, 12, v22
  v_lshlrev_b32 v25, 2, v22
  v_xor_b32 v25, v25, v8
  v_lshlrev_b32 v59, 4, v25
  v_mov_b32 v60, v10
  v_lshl_add_u32 v7, v10, 10, v59
  v_lshlrev_b32 v22, 5, v22
  v_lshl_add_u32 v22, v14, 3, v22
  v_bfe_u32 v23, v1, 2, 2
  v_xor_b32 v25, 2, v23
  v_lshlrev_b32 v27, 12, v24
  v_lshl_add_u32 v27, v23, 8, v27
  v_add_u32 v27, v27, v22
  v_add_u32 v27, 2048, v27
  v_lshl_add_u32 v28, v25, 6, v27
  v_and_b32 v46, 1, v9
  v_lshrrev_b32 v47, 1, v9
  v_lshl_add_u32 v46, v46, 1, v47
  v_lshl_add_u32 v46, v8, 3, v46
  s_lshl_b32 s86, s56, 8
  s_add_u32 s86, s86, 159744
  v_lshl_add_u32 v46, v46, 2, s86
  v_and_b32 v27, 15, v1
  v_lshl_add_u32 v26, v27, 7, v26
  s_lshl_b32 s86, s60, 13
  v_add_u32 v26, s86, v26
  v_bfe_u32 v27, v1, 1, 3
  v_xor_b32 v27, v27, v24
  v_lshl_add_u32 v29, v27, 4, v26
  s_and_b32 s86, s2, 6
  s_lshr_b32 s87, s2, 3
  s_lshl_b32 s66, s86, 1
  s_and_b32 s86, s87, 3
  s_add_u32 s66, s66, s86
  s_bfe_u32 s67, s87, 0x10002
  s_lshr_b32 s68, s87, 3
  s_and_b32 s86, s2, 1
  s_lshl_b32 s86, s86, 2
  s_add_u32 s68, s68, s86
  s_add_u32 s70, s69, 256
  s_sub_u32 s87, s58, 8
  s_mul_i32 s88, s87, 448
  s_add_u32 s89, s88, 384
  s_mul_i32 s86, s87, 14
  s_add_u32 s86, s86, 32
  s_add_u32 s72, s86, 2
  s_add_u32 s82, s86, 12
  s_bitcmp1_b32 s58, 0
  s_cselect_b32 s71, s88, s89
  s_cselect_b32 s72, s72, s86
  s_cselect_b32 s82, s86, s82
  s_add_u32 s81, s72, 8
  s_lshl_b32 s86, s57, 2
  s_add_u32 s86, s86, s60
  s_mul_i32 s77, s86, 147456
  s_lshr_b32 s86, s86, 1
  s_lshl_b32 s86, s86, 3
  s_lshr_b32 s87, s58, 1
  s_add_u32 s86, s86, s87
  s_lshl_b32 s86, s86, 7
  s_and_b32 s87, s58, 1
  s_lshl_b32 s87, s87, 4
  s_add_u32 s86, s86, s87
  s_and_b32 s87, s60, 1
  s_lshl_b32 s87, s87, 3
  s_add_u32 s86, s86, s87
  s_add_u32 m0, s65, 2048
  s_add_u32 s80, s86, 10698756
  buffer_load_dwordx4 v4, s[36:39], s64 offen lds
  s_add_u32 m0, s65, 0
  s_nop 0
  buffer_load_dwordx4 v2, s[32:35], s63 offen lds
  s_add_u32 m0, s65, 3072
  s_add_u32 s64, s64, s3
  buffer_load_dwordx4 v4, s[36:39], s64 offen lds
  s_add_u32 m0, s65, 1024
  s_nop 0
  buffer_load_dwordx4 v3, s[32:35], s63 offen lds
  s_mov_b32 s44, s20
  s_mov_b32 s45, s21
  s_mov_b32 s46, 1835008
  s_mul_i32 s65, s60, 458752
  s_mul_i32 s86, s68, 128
  s_add_u32 s65, s65, s86
  s_add_u32 s65, s65, 0
  s_mul_i32 s64, s60, 6144
  s_add_u32 s64, s64, 107520
  v_lshl_add_u32 v61, v24, 2, v23
  v_lshl_add_u32 v61, v61, 7, v22
  v_lshrrev_b32 v60, 1, v23
  v_lshl_add_u32 v61, v60, 6, v61
  v_add_u32 v4, s64, v61
  v_xor_b32 v5, 64, v4
  v_add_u32 v3, 147456, v15
  s_lshl_b32 s86, s66, 1
  s_add_u32 s86, s86, s67
  s_lshl_b32 s90, s86, 10
  s_mul_i32 s101, s68, 0
  s_add_u32 s101, s101, s86
  s_mul_i32 s63, s86, 294912
  s_mul_i32 s86, s60, 28672
  s_add_u32 s63, s63, s86
  s_add_u32 s63, s63, 32768
  s_lshl_b32 s86, s60, 7
  s_add_u32 s90, s90, s86
  s_add_u32 s90, s90, 10699264
  v_lshl_add_u32 v59, v24, 2, s60
  v_and_b32 v127, 31, v1
  v_lshl_add_u32 v126, v59, 6, s69
  v_mov_b32 v125, s71
  v_cmp_le_u32 vcc, 6, v59
  s_mov_b32 s48, s18
  s_mov_b32 s49, s19
  v_cndmask_b32 v126, v126, v125, vcc
  s_mov_b32 s50, 3584
  s_mov_b32 s51, 0x20000
  v_lshl_add_u32 v126, v127, 1, v126
  v_lshlrev_b32 v124, 2, v126
  v_add_u32 v124, 12288, v124
  v_mov_b32 v123, v126
  s_lshl_b32 s88, s57, 2
  s_add_u32 s88, s88, s60
  s_lshl_b32 s88, s88, 5
  v_add_lshl_u32 v125, v127, s88, 3
  v_lshlrev_b32 v59, 8, v59
  v_lshl_add_u32 v59, v127, 3, v59
  v_add_u32 v59, 159744, v59
  s_lshl_b32 s88, s60, 7
  s_add_u32 s88, s88, 161792
  v_lshl_add_u32 v58, v127, 2, s88
  v_mov_b32 v12, v28
  v_xor_b32 v13, 64, v28
  v_mov_b32 v8, v29
  v_xor_b32 v9, 32, v29
  v_xor_b32 v10, 64, v29
  v_xor_b32 v11, 96, v29
  s_waitcnt vmcnt(6)
  v_dot2_f32_bf16 v44, v32, s74, 0
  v_dot2_f32_bf16 v45, v32, v32, 0
  v_dot2_f32_bf16 v44, v33, s74, v44
  v_dot2_f32_bf16 v45, v33, v33, v45
  v_dot2_f32_bf16 v44, v34, s74, v44
  v_dot2_f32_bf16 v45, v34, v34, v45
  v_dot2_f32_bf16 v44, v35, s74, v44
  v_dot2_f32_bf16 v45, v35, v35, v45
  s_waitcnt vmcnt(4)
  v_dot2_f32_bf16 v48, v36, s75, 0
  v_dot2_f32_bf16 v49, v36, s76, 0
  v_dot2_f32_bf16 v50, v37, s75, 0
  v_dot2_f32_bf16 v51, v37, s76, 0
  v_dot2_f32_bf16 v52, v38, s75, 0
  v_dot2_f32_bf16 v53, v38, s76, 0
  v_dot2_f32_bf16 v54, v39, s75, 0
  v_dot2_f32_bf16 v55, v39, s76, 0
  v_dot2_f32_bf16 v48, v40, s75, v48
  v_dot2_f32_bf16 v49, v40, s76, v49
  v_dot2_f32_bf16 v50, v41, s75, v50
  v_dot2_f32_bf16 v51, v41, s76, v51
  v_dot2_f32_bf16 v52, v42, s75, v52
  v_dot2_f32_bf16 v53, v42, s76, v53
  v_dot2_f32_bf16 v54, v43, s75, v54
  v_dot2_f32_bf16 v55, v43, s76, v55
  v_permlane32_swap_b32 v44, v45
  v_permlane32_swap_b32 v48, v49
  v_permlane32_swap_b32 v50, v51
  v_permlane32_swap_b32 v52, v53
  v_permlane32_swap_b32 v54, v55
  v_add_f32 v56, v44, v45
  v_add_f32 v48, v48, v49
  v_add_f32 v50, v50, v51
  v_add_f32 v52, v52, v53
  v_add_f32 v54, v54, v55
  v_mov_b32 v57, v56
  v_permlane16_swap_b32 v48, v50
  v_permlane16_swap_b32 v52, v54
  v_add_f32 v48, v48, v50
  v_add_f32 v52, v52, v54
  v_permlane16_swap_b32 v56, v57
  v_add_f32_dpp v48, v48, v48 row_ror:8 row_mask:0xf bank_mask:0xf
  v_add_f32_dpp v52, v52, v52 row_ror:8 row_mask:0xf bank_mask:0xf
  v_add_f32 v56, v56, v57
  ds_write2_b32 v46, v48, v52 offset0:0 offset1:4
  s_waitcnt lgkmcnt(0)
  s_mul_i32 s59, s73, 0x9E3779B1
  s_add_u32 s59, s59, 0x7F4A7C15
  s_and_b32 s59, s59, 0xfffffffc
  s_barrier
  v_lshlrev_b32 v57, 2, v1
  v_add_u32 v57, 159744, v57
  ds_read2st64_b32 v[48:49], v57 offset0:0 offset1:1
  ds_read2st64_b32 v[50:51], v57 offset0:2 offset1:3
  ds_read2st64_b32 v[52:53], v57 offset0:4 offset1:5
  ds_read2st64_b32 v[54:55], v57 offset0:6 offset1:7
  v_add_f32_dpp v56, v56, v56 row_ror:8 row_mask:0xf bank_mask:0xf
  s_nop 1
  v_add_f32_dpp v56, v56, v56 row_ror:4 row_mask:0xf bank_mask:0xf
  s_lshl_b32 s88, s98, 3
  s_nop 0
  v_add_f32_dpp v56, v56, v56 row_ror:2 row_mask:0xf bank_mask:0xf
  s_add_u32 s88, s88, 10485760
  v_mov_b32 v117, s59
  v_add_f32_dpp v56, v56, v56 row_ror:1 row_mask:0xf bank_mask:0xf
  v_mov_b32 v112, 0x3b000000
  v_readlane_b32 s86, v56, 0
  v_readlane_b32 s87, v56, 32
  s_nop 0
  v_mul_f32 v113, s86, v112
  v_mul_f32 v114, s87, v112
  v_fma_f32 v114, -v113, v113, v114
  v_max_f32 v114, 0, v114
  v_cvt_pk_bf16_f32 v115, v113, v114
  v_and_b32 v115, 0xffff0000, v115
  v_add_f32 v115, 0x3727c5ac, v115
  v_cvt_pk_bf16_f32 v115, v115, v115
  v_and_b32 v115, 0xffff0000, v115
  v_sqrt_f32 v115, v115
  s_nop 0
  v_cvt_pk_bf16_f32 v116, v113, v115
  s_mov_b32 s98, s88
  s_waitcnt lgkmcnt(0)
  v_add_f32 v48, v48, v49
  v_add_f32 v50, v50, v51
  v_add_f32 v52, v52, v53
  v_add_f32 v54, v54, v55
  v_add_f32 v48, v48, v50
  s_lshl_b32 s86, s99, 9
  v_add_f32 v52, v52, v54
  s_mul_i32 s87, s100, 26624
  s_add_u32 s86, s86, s87
  s_add_u32 s86, s86, 10551296
  v_add_f32 v118, v48, v52
  v_mov_b32 v119, s59
  v_lshlrev_b32 v57, 3, v1
  s_cmp_eq_u32 s60, 0
  s_cselect_b32 s86, s86, 2146435072
  s_cmp_ge_u32 s99, 52
  s_cselect_b32 s86, 2146435072, s86
  s_mov_b32 s99, s86
  s_waitcnt vmcnt(0)
  s_barrier
  ds_read_b64_tr_b16 v[32:33], v12 offset:0
  ds_read_b64_tr_b16 v[34:35], v12 offset:1024
  ds_read_b128 v[224:227], v8 offset:0
  ds_read_b64_tr_b16 v[36:37], v13 offset:0
  ds_read_b64_tr_b16 v[38:39], v13 offset:1024
  s_waitcnt lgkmcnt(0)
  v_mfma_f32_32x32x16_bf16 v[64:79], v[32:35], v[224:227], 0
  ds_read_b64_tr_b16 v[40:41], v12 offset:8192
  ds_read_b64_tr_b16 v[42:43], v12 offset:9216
  ds_read_b128 v[228:231], v9 offset:0
  ds_read_b64_tr_b16 v[44:45], v13 offset:8192
  ds_read_b64_tr_b16 v[46:47], v13 offset:9216
  v_mfma_f32_32x32x16_bf16 v[80:95], v[36:39], v[224:227], 0
  s_mov_b64 exec, 1
  buffer_store_dwordx2 v[116:117], off, s[40:43], s98 sc1
  s_mov_b64 exec, -1
  buffer_store_dwordx2 v[118:119], v57, s[40:43], s99 offen sc1
  buffer_load_ushort v122, v123, s[48:51], 0 offen
  s_waitcnt lgkmcnt(0)
  v_mfma_f32_32x32x16_bf16 v[64:79], v[40:43], v[228:231], v[64:79]
  ds_read_b64_tr_b16 v[32:33], v12 offset:16384
  ds_read_b64_tr_b16 v[34:35], v12 offset:17408
  ds_read_b128 v[224:227], v10 offset:0
  ds_read_b64_tr_b16 v[36:37], v13 offset:16384
  ds_read_b64_tr_b16 v[38:39], v13 offset:17408
  v_mfma_f32_32x32x16_bf16 v[80:95], v[44:47], v[228:231], v[80:95]
  s_waitcnt lgkmcnt(0)
  v_mfma_f32_32x32x16_bf16 v[64:79], v[32:35], v[224:227], v[64:79]
  ds_read_b64_tr_b16 v[40:41], v12 offset:24576
  ds_read_b64_tr_b16 v[42:43], v12 offset:25600
  ds_read_b128 v[228:231], v11 offset:0
  ds_read_b64_tr_b16 v[44:45], v13 offset:24576
  ds_read_b64_tr_b16 v[46:47], v13 offset:25600
  v_mfma_f32_32x32x16_bf16 v[80:95], v[36:39], v[224:227], v[80:95]
  s_barrier
  s_waitcnt lgkmcnt(0)
  v_mfma_f32_32x32x16_bf16 v[64:79], v[40:43], v[228:231], v[64:79]
  ds_read_b64_tr_b16 v[32:33], v12 offset:32768
  ds_read_b64_tr_b16 v[34:35], v12 offset:33792
  ds_read_b128 v[224:227], v8 offset:32768
  ds_read_b64_tr_b16 v[36:37], v13 offset:32768
  ds_read_b64_tr_b16 v[38:39], v13 offset:33792
  v_mfma_f32_32x32x16_bf16 v[80:95], v[44:47], v[228:231], v[80:95]
  s_waitcnt lgkmcnt(0)
  v_mfma_f32_32x32x16_bf16 v[64:79], v[32:35], v[224:227], v[64:79]
  ds_read_b64_tr_b16 v[40:41], v12 offset:40960
  ds_read_b64_tr_b16 v[42:43], v12 offset:41984
  ds_read_b128 v[228:231], v9 offset:32768
  ds_read_b64_tr_b16 v[44:45], v13 offset:40960
  ds_read_b64_tr_b16 v[46:47], v13 offset:41984
  v_mfma_f32_32x32x16_bf16 v[80:95], v[36:39], v[224:227], v[80:95]
  s_waitcnt lgkmcnt(0)
  v_mfma_f32_32x32x16_bf16 v[64:79], v[40:43], v[228:231], v[64:79]
  ds_read_b64_tr_b16 v[32:33], v12 offset:49152
  ds_read_b64_tr_b16 v[34:35], v12 offset:50176
  ds_read_b128 v[224:227], v10 offset:32768
  ds_read_b64_tr_b16 v[36:37], v13 offset:49152
  ds_read_b64_tr_b16 v[38:39], v13 offset:50176
  v_mfma_f32_32x32x16_bf16 v[80:95], v[44:47], v[228:231], v[80:95]
  s_waitcnt lgkmcnt(0)
  v_mfma_f32_32x32x16_bf16 v[64:79], v[32:35], v[224:227], v[64:79]
  ds_read_b64_tr_b16 v[40:41], v12 offset:57344
  ds_read_b64_tr_b16 v[42:43], v12 offset:58368
  ds_read_b128 v[228:231], v11 offset:32768
  ds_read_b64_tr_b16 v[44:45], v13 offset:57344
  ds_read_b64_tr_b16 v[46:47], v13 offset:58368
  v_mfma_f32_32x32x16_bf16 v[80:95], v[36:39], v[224:227], v[80:95]
  s_barrier
  s_waitcnt lgkmcnt(0)
  v_mfma_f32_32x32x16_bf16 v[64:79], v[40:43], v[228:231], v[64:79]
  v_xor_b32 v8, 0x10000, v8
  v_xor_b32 v9, 0x10000, v9
  v_xor_b32 v10, 0x10000, v10
  v_xor_b32 v11, 0x10000, v11
  v_xor_b32 v12, 0x10000, v12
  v_xor_b32 v13, 0x10000, v13
  ds_read_b64_tr_b16 v[32:33], v12 offset:0
  ds_read_b64_tr_b16 v[34:35], v12 offset:1024
  ds_read_b128 v[224:227], v8 offset:0
  ds_read_b64_tr_b16 v[36:37], v13 offset:0
  ds_read_b64_tr_b16 v[38:39], v13 offset:1024
  v_mfma_f32_32x32x16_bf16 v[80:95], v[44:47], v[228:231], v[80:95]
  s_waitcnt lgkmcnt(0)
  v_mfma_f32_32x32x16_bf16 v[64:79], v[32:35], v[224:227], v[64:79]
  ds_read_b64_tr_b16 v[40:41], v12 offset:8192
  ds_read_b64_tr_b16 v[42:43], v12 offset:9216
  ds_read_b128 v[228:231], v9 offset:0
  ds_read_b64_tr_b16 v[44:45], v13 offset:8192
  ds_read_b64_tr_b16 v[46:47], v13 offset:9216
  v_mfma_f32_32x32x16_bf16 v[80:95], v[36:39], v[224:227], v[80:95]
  s_waitcnt lgkmcnt(0)
  v_mfma_f32_32x32x16_bf16 v[64:79], v[40:43], v[228:231], v[64:79]
  ds_read_b64_tr_b16 v[32:33], v12 offset:16384
  ds_read_b64_tr_b16 v[34:35], v12 offset:17408
  ds_read_b128 v[224:227], v10 offset:0
  ds_read_b64_tr_b16 v[36:37], v13 offset:16384
  ds_read_b64_tr_b16 v[38:39], v13 offset:17408
  v_mfma_f32_32x32x16_bf16 v[80:95], v[44:47], v[228:231], v[80:95]
  s_mov_b32 s86, 10551296
  buffer_load_dwordx2 v[112:113], v124, s[40:43], s86 offen sc1
  s_waitcnt lgkmcnt(0)
  v_mfma_f32_32x32x16_bf16 v[64:79], v[32:35], v[224:227], v[64:79]
  ds_read_b64_tr_b16 v[40:41], v12 offset:24576
  ds_read_b64_tr_b16 v[42:43], v12 offset:25600
  ds_read_b128 v[228:231], v11 offset:0
  ds_read_b64_tr_b16 v[44:45], v13 offset:24576
  ds_read_b64_tr_b16 v[46:47], v13 offset:25600
  v_mfma_f32_32x32x16_bf16 v[80:95], v[36:39], v[224:227], v[80:95]
  s_mov_b32 s86, 10577920
  buffer_load_dwordx2 v[114:115], v124, s[40:43], s86 offen sc1
  s_barrier
  s_waitcnt lgkmcnt(0)
  v_mfma_f32_32x32x16_bf16 v[64:79], v[40:43], v[228:231], v[64:79]
  ds_read_b64_tr_b16 v[32:33], v12 offset:32768
  ds_read_b64_tr_b16 v[34:35], v12 offset:33792
  ds_read_b128 v[224:227], v8 offset:32768
  ds_read_b64_tr_b16 v[36:37], v13 offset:32768
  ds_read_b64_tr_b16 v[38:39], v13 offset:33792
  v_mfma_f32_32x32x16_bf16 v[80:95], v[44:47], v[228:231], v[80:95]
  s_mov_b32 s86, 10604544
  buffer_load_dwordx2 v[116:117], v124, s[40:43], s86 offen sc1
  s_waitcnt lgkmcnt(0)
  v_mfma_f32_32x32x16_bf16 v[64:79], v[32:35], v[224:227], v[64:79]
  ds_read_b64_tr_b16 v[40:41], v12 offset:40960
  ds_read_b64_tr_b16 v[42:43], v12 offset:41984
  ds_read_b128 v[228:231], v9 offset:32768
  ds_read_b64_tr_b16 v[44:45], v13 offset:40960
  ds_read_b64_tr_b16 v[46:47], v13 offset:41984
  v_mfma_f32_32x32x16_bf16 v[80:95], v[36:39], v[224:227], v[80:95]
  s_mov_b32 s86, 10631168
  buffer_load_dwordx2 v[118:119], v124, s[40:43], s86 offen sc1
  s_waitcnt lgkmcnt(0)
  v_mfma_f32_32x32x16_bf16 v[64:79], v[40:43], v[228:231], v[64:79]
  ds_read_b64_tr_b16 v[32:33], v12 offset:49152
  ds_read_b64_tr_b16 v[34:35], v12 offset:50176
  ds_read_b128 v[224:227], v10 offset:32768
  ds_read_b64_tr_b16 v[36:37], v13 offset:49152
  ds_read_b64_tr_b16 v[38:39], v13 offset:50176
  v_mfma_f32_32x32x16_bf16 v[80:95], v[44:47], v[228:231], v[80:95]
  s_mov_b32 s86, 10485760
  buffer_load_dwordx2 v[120:121], v125, s[40:43], s86 offen sc1
  s_waitcnt lgkmcnt(0)
  v_mfma_f32_32x32x16_bf16 v[64:79], v[32:35], v[224:227], v[64:79]
  ds_read_b64_tr_b16 v[40:41], v12 offset:57344
  ds_read_b64_tr_b16 v[42:43], v12 offset:58368
  ds_read_b128 v[228:231], v11 offset:32768
  ds_read_b64_tr_b16 v[44:45], v13 offset:57344
  ds_read_b64_tr_b16 v[46:47], v13 offset:58368
  v_mfma_f32_32x32x16_bf16 v[80:95], v[36:39], v[224:227], v[80:95]
  s_barrier
  s_waitcnt lgkmcnt(0)
  v_mfma_f32_32x32x16_bf16 v[64:79], v[40:43], v[228:231], v[64:79]
  v_xor_b32 v8, 0x10000, v8
  v_xor_b32 v9, 0x10000, v9
  v_xor_b32 v10, 0x10000, v10
  v_xor_b32 v11, 0x10000, v11
  v_xor_b32 v12, 0x10000, v12
  v_xor_b32 v13, 0x10000, v13
  ds_read_b64_tr_b16 v[32:33], v12 offset:0
  ds_read_b64_tr_b16 v[34:35], v12 offset:1024
  ds_read_b128 v[224:227], v8 offset:0
  ds_read_b64_tr_b16 v[36:37], v13 offset:0
  ds_read_b64_tr_b16 v[38:39], v13 offset:1024
  v_mfma_f32_32x32x16_bf16 v[80:95], v[44:47], v[228:231], v[80:95]
  s_waitcnt lgkmcnt(0)
  v_mfma_f32_32x32x16_bf16 v[64:79], v[32:35], v[224:227], v[64:79]
  ds_read_b64_tr_b16 v[40:41], v12 offset:8192
  ds_read_b64_tr_b16 v[42:43], v12 offset:9216
  ds_read_b128 v[228:231], v9 offset:0
  ds_read_b64_tr_b16 v[44:45], v13 offset:8192
  ds_read_b64_tr_b16 v[46:47], v13 offset:9216
  v_mfma_f32_32x32x16_bf16 v[80:95], v[36:39], v[224:227], v[80:95]
  s_waitcnt lgkmcnt(0)
  v_mfma_f32_32x32x16_bf16 v[64:79], v[40:43], v[228:231], v[64:79]
  ds_read_b64_tr_b16 v[32:33], v12 offset:16384
  ds_read_b64_tr_b16 v[34:35], v12 offset:17408
  ds_read_b128 v[224:227], v10 offset:0
  ds_read_b64_tr_b16 v[36:37], v13 offset:16384
  ds_read_b64_tr_b16 v[38:39], v13 offset:17408
  v_mfma_f32_32x32x16_bf16 v[80:95], v[44:47], v[228:231], v[80:95]
  s_waitcnt lgkmcnt(0)
  v_mfma_f32_32x32x16_bf16 v[64:79], v[32:35], v[224:227], v[64:79]
  ds_read_b64_tr_b16 v[40:41], v12 offset:24576
  ds_read_b64_tr_b16 v[42:43], v12 offset:25600
  ds_read_b128 v[228:231], v11 offset:0
  ds_read_b64_tr_b16 v[44:45], v13 offset:24576
  ds_read_b64_tr_b16 v[46:47], v13 offset:25600
  v_mfma_f32_32x32x16_bf16 v[80:95], v[36:39], v[224:227], v[80:95]
  s_barrier
  s_waitcnt lgkmcnt(0)
  v_mfma_f32_32x32x16_bf16 v[64:79], v[40:43], v[228:231], v[64:79]
  ds_read_b64_tr_b16 v[32:33], v12 offset:32768
  ds_read_b64_tr_b16 v[34:35], v12 offset:33792
  ds_read_b128 v[224:227], v8 offset:32768
  ds_read_b64_tr_b16 v[36:37], v13 offset:32768
  ds_read_b64_tr_b16 v[38:39], v13 offset:33792
  v_mfma_f32_32x32x16_bf16 v[80:95], v[44:47], v[228:231], v[80:95]
  s_waitcnt lgkmcnt(0)
  v_mfma_f32_32x32x16_bf16 v[64:79], v[32:35], v[224:227], v[64:79]
  ds_read_b64_tr_b16 v[40:41], v12 offset:40960
  ds_read_b64_tr_b16 v[42:43], v12 offset:41984
  ds_read_b128 v[228:231], v9 offset:32768
  ds_read_b64_tr_b16 v[44:45], v13 offset:40960
  ds_read_b64_tr_b16 v[46:47], v13 offset:41984
  v_mfma_f32_32x32x16_bf16 v[80:95], v[36:39], v[224:227], v[80:95]
  s_waitcnt vmcnt(0)
  v_xor_b32 v126, s59, v113
  v_xor_b32 v127, s59, v115
  v_xor_b32 v123, s59, v117
  v_or3_b32 v126, v126, v127, v123
  v_xor_b32 v127, s59, v119
  v_xor_b32 v123, s59, v121
  v_or3_b32 v126, v126, v127, v123
  v_cmp_ne_u32 vcc, 0, v126
  s_cbranch_vccz L_gok_9
  s_mov_b32 s89, 0
L_gspin_10:
  s_sleep 2
  s_mov_b32 s86, 10551296
  buffer_load_dwordx2 v[112:113], v124, s[40:43], s86 offen sc1
  s_mov_b32 s86, 10577920
  buffer_load_dwordx2 v[114:115], v124, s[40:43], s86 offen sc1
  s_mov_b32 s86, 10604544
  buffer_load_dwordx2 v[116:117], v124, s[40:43], s86 offen sc1
  s_mov_b32 s86, 10631168
  buffer_load_dwordx2 v[118:119], v124, s[40:43], s86 offen sc1
  s_mov_b32 s86, 10485760
  buffer_load_dwordx2 v[120:121], v125, s[40:43], s86 offen sc1
  s_waitcnt vmcnt(0)
  v_xor_b32 v126, s59, v113
  v_xor_b32 v127, s59, v115
  v_xor_b32 v123, s59, v117
  v_or3_b32 v126, v126, v127, v123
  v_xor_b32 v127, s59, v119
  v_xor_b32 v123, s59, v121
  v_or3_b32 v126, v126, v127, v123
  v_cmp_ne_u32 vcc, 0, v126
  s_cbranch_vccz L_gok_9
  s_add_u32 s89, s89, 1
  s_cmp_lt_u32 s89, 0x8000
  s_cbranch_scc1 L_gspin_10
L_gok_9:
  s_nop 0
  s_waitcnt lgkmcnt(0)
  v_mfma_f32_32x32x16_bf16 v[64:79], v[40:43], v[228:231], v[64:79]
  ds_read_b64_tr_b16 v[32:33], v12 offset:49152
  ds_read_b64_tr_b16 v[34:35], v12 offset:50176
  ds_read_b128 v[224:227], v10 offset:32768
  ds_read_b64_tr_b16 v[36:37], v13 offset:49152
  ds_read_b64_tr_b16 v[38:39], v13 offset:50176
  v_mfma_f32_32x32x16_bf16 v[80:95], v[44:47], v[228:231], v[80:95]
  ds_write_b32 v58, v120
  v_add_f32 v112, v112, v114
  v_add_f32 v116, v116, v118
  v_mov_b32 v126, 0
  s_mov_b32 s52, s12
  s_mov_b32 s53, s13
  s_mov_b32 s54, 524288
  s_mov_b32 s55, 0x20000
  v_and_b32 v61, 3, v1
  v_lshlrev_b32 v61, 7, v61
  v_bfe_u32 v60, v1, 2, 3
  v_lshl_add_u32 v61, v60, 10, v61
  s_bfe_u32 s84, s2, 0x40003
  s_lshl_b32 s84, s84, 2
  s_add_u32 s84, s84, s60
  s_mul_i32 s5, s84, 8192
  s_and_b32 s84, s2, 1
  s_lshl_b32 s84, s84, 9
  s_add_u32 s5, s5, s84
  buffer_load_dword v242, v61, s[52:55], s5 offen
  s_waitcnt lgkmcnt(1)
  v_mfma_f32_32x32x16_bf16 v[64:79], v[32:35], v[224:227], v[64:79]
  ds_read_b64_tr_b16 v[40:41], v12 offset:57344
  ds_read_b64_tr_b16 v[42:43], v12 offset:58368
  ds_read_b128 v[228:231], v11 offset:32768
  ds_read_b64_tr_b16 v[44:45], v13 offset:57344
  ds_read_b64_tr_b16 v[46:47], v13 offset:58368
  v_mfma_f32_32x32x16_bf16 v[80:95], v[36:39], v[224:227], v[80:95]
  v_add_f32 v112, v112, v116
  v_mov_b32 v127, 162304
  v_cvt_pk_bf16_f32 v113, v112, v112
  ds_write_b32 v127, v126
  s_barrier
  s_waitcnt lgkmcnt(1)
  v_mfma_f32_32x32x16_bf16 v[64:79], v[40:43], v[228:231], v[64:79]
  v_xor_b32 v8, 0x10000, v8
  v_xor_b32 v9, 0x10000, v9
  v_xor_b32 v10, 0x10000, v10
  v_xor_b32 v11, 0x10000, v11
  v_xor_b32 v12, 0x10000, v12
  v_xor_b32 v13, 0x10000, v13
  ds_read_b64_tr_b16 v[32:33], v12 offset:0
  ds_read_b64_tr_b16 v[34:35], v12 offset:1024
  ds_read_b128 v[224:227], v8 offset:0
  ds_read_b64_tr_b16 v[36:37], v13 offset:0
  ds_read_b64_tr_b16 v[38:39], v13 offset:1024
  v_mfma_f32_32x32x16_bf16 v[80:95], v[44:47], v[228:231], v[80:95]
  v_and_b32 v114, 0xffff0000, v113
  v_sub_f32 v112, v112, v114
  v_and_b32 v113, 0xffff, v113
  v_cvt_pk_bf16_f32 v114, v112, v112
  s_waitcnt lgkmcnt(0)
  v_mfma_f32_32x32x16_bf16 v[64:79], v[32:35], v[224:227], v[64:79]
  ds_read_b64_tr_b16 v[40:41], v12 offset:8192
  ds_read_b64_tr_b16 v[42:43], v12 offset:9216
  ds_read_b128 v[228:231], v9 offset:0
  ds_read_b64_tr_b16 v[44:45], v13 offset:8192
  ds_read_b64_tr_b16 v[46:47], v13 offset:9216
  v_mfma_f32_32x32x16_bf16 v[80:95], v[36:39], v[224:227], v[80:95]
  v_and_b32 v115, 0xffff0000, v114
  v_sub_f32 v112, v112, v115
  v_or_b32 v114, v113, v115
  v_cvt_pk_bf16_f32 v116, v112, 0
  s_waitcnt lgkmcnt(0)
  v_mfma_f32_32x32x16_bf16 v[64:79], v[40:43], v[228:231], v[64:79]
  ds_read_b64_tr_b16 v[32:33], v12 offset:16384
  ds_read_b64_tr_b16 v[34:35], v12 offset:17408
  ds_read_b128 v[224:227], v10 offset:0
  ds_read_b64_tr_b16 v[36:37], v13 offset:16384
  ds_read_b64_tr_b16 v[38:39], v13 offset:17408
  v_mfma_f32_32x32x16_bf16 v[80:95], v[44:47], v[228:231], v[80:95]
  v_lshl_or_b32 v115, v122, 16, v116
  ds_write_b64 v59, v[114:115]
  v_cmp_gt_u32 vcc, 32, v1
  v_xor_b32 v120, 0x8000, v120
  s_waitcnt lgkmcnt(1)
  v_mfma_f32_32x32x16_bf16 v[64:79], v[32:35], v[224:227], v[64:79]
  ds_read_b64_tr_b16 v[40:41], v12 offset:24576
  ds_read_b64_tr_b16 v[42:43], v12 offset:25600
  ds_read_b128 v[228:231], v11 offset:0
  ds_read_b64_tr_b16 v[44:45], v13 offset:24576
  ds_read_b64_tr_b16 v[46:47], v13 offset:25600
  v_mfma_f32_32x32x16_bf16 v[80:95], v[36:39], v[224:227], v[80:95]
  v_and_b32 v121, 0xffff, v120
  v_lshl_or_b32 v121, v121, 16, v121
  v_cndmask_b32 v16, 0, v121, vcc
  v_cndmask_b32 v17, 0, v120, vcc
  s_barrier
  s_waitcnt lgkmcnt(0)
  v_mfma_f32_32x32x16_bf16 v[64:79], v[40:43], v[228:231], v[64:79]
  ds_read_b64_tr_b16 v[32:33], v12 offset:32768
  ds_read_b64_tr_b16 v[34:35], v12 offset:33792
  ds_read_b128 v[224:227], v8 offset:32768
  ds_read_b64_tr_b16 v[36:37], v13 offset:32768
  ds_read_b64_tr_b16 v[38:39], v13 offset:33792
  v_mfma_f32_32x32x16_bf16 v[80:95], v[44:47], v[228:231], v[80:95]
  v_and_b32 v121, 0xffff0000, v120
  v_mov_b32 v18, 0
  v_mov_b32 v19, 0
  v_rcp_f32 v20, v121
  s_waitcnt lgkmcnt(0)
  v_mfma_f32_32x32x16_bf16 v[64:79], v[32:35], v[224:227], v[64:79]
  ds_read_b64_tr_b16 v[40:41], v12 offset:40960
  ds_read_b64_tr_b16 v[42:43], v12 offset:41984
  ds_read_b128 v[228:231], v9 offset:32768
  ds_read_b64_tr_b16 v[44:45], v13 offset:40960
  ds_read_b64_tr_b16 v[46:47], v13 offset:41984
  v_mfma_f32_32x32x16_bf16 v[80:95], v[36:39], v[224:227], v[80:95]
  s_waitcnt lgkmcnt(0)
  v_mfma_f32_32x32x16_bf16 v[64:79], v[40:43], v[228:231], v[64:79]
  ds_read_b64_tr_b16 v[32:33], v12 offset:49152
  ds_read_b64_tr_b16 v[34:35], v12 offset:50176
  ds_read_b128 v[224:227], v10 offset:32768
  ds_read_b64_tr_b16 v[36:37], v13 offset:49152
  ds_read_b64_tr_b16 v[38:39], v13 offset:50176
  v_mfma_f32_32x32x16_bf16 v[80:95], v[44:47], v[228:231], v[80:95]
  s_waitcnt lgkmcnt(0)
  v_mfma_f32_32x32x16_bf16 v[64:79], v[32:35], v[224:227], v[64:79]
  ds_read_b64_tr_b16 v[40:41], v12 offset:57344
  ds_read_b64_tr_b16 v[42:43], v12 offset:58368
  ds_read_b128 v[228:231], v11 offset:32768
  ds_read_b64_tr_b16 v[44:45], v13 offset:57344
  ds_read_b64_tr_b16 v[46:47], v13 offset:58368
  v_mfma_f32_32x32x16_bf16 v[80:95], v[36:39], v[224:227], v[80:95]
  s_barrier
  v_and_b32 v126, 31, v1
  v_lshlrev_b32 v127, 3, v126
  v_add_u32 v127, 159744, v127
  v_mov_b32 v24, 0
  v_mov_b32 v25, 0
  v_mov_b32 v28, 0
  v_mov_b32 v29, 0
  ds_read_b64 v[22:23], v127 offset:512
  ds_read_b64 v[26:27], v127 offset:768
  s_waitcnt lgkmcnt(2)
  v_mfma_f32_32x32x16_bf16 v[64:79], v[40:43], v[228:231], v[64:79]
  v_mfma_f32_32x32x16_bf16 v[80:95], v[44:47], v[228:231], v[80:95]
  s_waitcnt lgkmcnt(0)
  v_mfma_f32_32x32x16_bf16 v[64:79], v[22:25], v[16:19], v[64:79]
  v_mfma_f32_32x32x16_bf16 v[80:95], v[26:29], v[16:19], v[80:95]
  s_barrier
  s_nop 9
  v_max_f32 v64, 0, v64
  v_max_f32 v65, 0, v65
  v_max_f32 v66, 0, v66
  v_max_f32 v67, 0, v67
  v_max_f32 v68, 0, v68
  v_max_f32 v69, 0, v69
  v_max_f32 v70, 0, v70
  v_max_f32 v71, 0, v71
  v_mul_f32 v64, v64, v64
  v_mul_f32 v65, v65, v65
  v_mul_f32 v66, v66, v66
  v_mul_f32 v67, v67, v67
  v_mul_f32 v68, v68, v68
  v_mul_f32 v69, v69, v69
  v_mul_f32 v70, v70, v70
  v_mul_f32 v71, v71, v71
  s_add_u32 s86, s72, 4
  s_lshl_b32 s86, s86, 10
  s_add_u32 s86, s86, s77
  v_cvt_pk_bf16_f32 v48, v64, v65
  v_cvt_pk_bf16_f32 v49, v66, v67
  v_cvt_pk_bf16_f32 v50, v68, v69
  v_cvt_pk_bf16_f32 v51, v70, v71
  buffer_store_dwordx4 v[48:51], v15, s[40:43], s86 offen offset:0 sc1
  v_max_f32 v72, 0, v72
  v_max_f32 v73, 0, v73
  v_max_f32 v74, 0, v74
  v_max_f32 v75, 0, v75
  v_max_f32 v76, 0, v76
  v_max_f32 v77, 0, v77
  v_max_f32 v78, 0, v78
  v_max_f32 v79, 0, v79
  v_mul_f32 v72, v72, v72
  v_mul_f32 v73, v73, v73
  v_mul_f32 v74, v74, v74
  v_mul_f32 v75, v75, v75
  v_mul_f32 v76, v76, v76
  v_mul_f32 v77, v77, v77
  v_mul_f32 v78, v78, v78
  v_mul_f32 v79, v79, v79
  v_cvt_pk_bf16_f32 v52, v72, v73
  v_cvt_pk_bf16_f32 v53, v74, v75
  v_cvt_pk_bf16_f32 v54, v76, v77
  v_cvt_pk_bf16_f32 v55, v78, v79
  buffer_store_dwordx4 v[52:55], v15, s[40:43], s86 offen offset:1024 sc1
  v_max_f32 v80, 0, v80
  v_max_f32 v81, 0, v81
  v_max_f32 v82, 0, v82
  v_max_f32 v83, 0, v83
  v_max_f32 v84, 0, v84
  v_max_f32 v85, 0, v85
  v_max_f32 v86, 0, v86
  v_max_f32 v87, 0, v87
  v_mul_f32 v80, v80, v80
  v_mul_f32 v81, v81, v81
  v_mul_f32 v82, v82, v82
  v_mul_f32 v83, v83, v83
  v_mul_f32 v84, v84, v84
  v_mul_f32 v85, v85, v85
  v_mul_f32 v86, v86, v86
  v_mul_f32 v87, v87, v87
  s_add_u32 s86, s72, 6
  s_lshl_b32 s86, s86, 10
  s_add_u32 s86, s86, s77
  v_cvt_pk_bf16_f32 v48, v80, v81
  v_cvt_pk_bf16_f32 v49, v82, v83
  v_cvt_pk_bf16_f32 v50, v84, v85
  v_cvt_pk_bf16_f32 v51, v86, v87
  buffer_store_dwordx4 v[48:51], v15, s[40:43], s86 offen offset:0 sc1
  v_max_f32 v88, 0, v88
  v_max_f32 v89, 0, v89
  v_max_f32 v90, 0, v90
  v_max_f32 v91, 0, v91
  v_max_f32 v92, 0, v92
  v_max_f32 v93, 0, v93
  v_max_f32 v94, 0, v94
  v_max_f32 v95, 0, v95
  v_mul_f32 v88, v88, v88
  v_mul_f32 v89, v89, v89
  v_mul_f32 v90, v90, v90
  v_mul_f32 v91, v91, v91
  v_mul_f32 v92, v92, v92
  v_mul_f32 v93, v93, v93
  v_mul_f32 v94, v94, v94
  v_mul_f32 v95, v95, v95
  v_cvt_pk_bf16_f32 v52, v88, v89
  v_cvt_pk_bf16_f32 v53, v90, v91
  v_cvt_pk_bf16_f32 v54, v92, v93
  v_cvt_pk_bf16_f32 v55, v94, v95
  buffer_store_dwordx4 v[52:55], v15, s[40:43], s86 offen offset:1024 sc1
  s_add_u32 m0, s64, 0
  s_add_u32 s5, s65, 0
  buffer_load_dwordx4 v7, s[44:47], s5 offen lds
  s_add_u32 m0, s64, 1024
  s_add_u32 s5, s5, 8192
  buffer_load_dwordx4 v7, s[44:47], s5 offen lds
  s_add_u32 m0, s64, 2048
  s_add_u32 s5, s65, 16384
  buffer_load_dwordx4 v7, s[44:47], s5 offen lds
  s_add_u32 m0, s64, 3072
  s_add_u32 s5, s5, 8192
  buffer_load_dwordx4 v7, s[44:47], s5 offen lds
  s_add_u32 m0, s64, 4096
  s_add_u32 s5, s65, 32768
  buffer_load_dwordx4 v7, s[44:47], s5 offen lds
  s_add_u32 m0, s64, 5120
  s_add_u32 s5, s5, 8192
  buffer_load_dwordx4 v7, s[44:47], s5 offen lds
  s_add_u32 m0, s64, 24576
  s_add_u32 s5, s65, 49152
  buffer_load_dwordx4 v7, s[44:47], s5 offen lds
  s_add_u32 m0, s64, 25600
  s_add_u32 s5, s5, 8192
  buffer_load_dwordx4 v7, s[44:47], s5 offen lds
  s_add_u32 m0, s64, 26624
  s_add_u32 s5, s65, 65536
  buffer_load_dwordx4 v7, s[44:47], s5 offen lds
  s_add_u32 m0, s64, 27648
  s_add_u32 s5, s5, 8192
  buffer_load_dwordx4 v7, s[44:47], s5 offen lds
  s_add_u32 m0, s64, 28672
  s_add_u32 s5, s65, 81920
  buffer_load_dwordx4 v7, s[44:47], s5 offen lds
  s_add_u32 m0, s64, 29696
  s_add_u32 s5, s5, 8192
  buffer_load_dwordx4 v7, s[44:47], s5 offen lds
  s_mov_b32 s83, s80
  s_add_u32 s31, s59, 1
  s_branch L_p3f
L_qkv:
  s_cmp_eq_u32 s61, 0
  s_cbranch_scc0 L_qkv_h1
  s_mov_b32 s36, s10
  s_mov_b32 s37, s11
  s_mov_b32 s38, 1572864
  s_mov_b32 s39, 0x20000
  s_movk_i32 s62, 3072
  s_movk_i32 s3, 12288
  v_xor_b32 v11, v8, v9
  v_lshlrev_b32 v11, 4, v11
  v_lshl_add_u32 v2, v10, 10, v11
  v_xor_b32 v3, 64, v2
  v_add_u32 v3, 8192, v3
  s_lshl_b32 s65, s56, 12
  s_lshl_b32 s63, s57, 3
  s_add_u32 s63, s63, s56
  s_lshl_b32 s63, s63, 14
  v_and_b32 v12, 15, v1
  v_lshlrev_b32 v13, 2, v9
  v_xor_b32 v12, v12, v13
  s_lshl_b32 s69, s58, 7
  s_add_u32 s69, s69, 1024
  v_lshrrev_b32 v13, 3, v12
  v_lshlrev_b32 v13, 10, v13
  v_and_b32 v12, 7, v12
  v_lshl_add_u32 v12, v12, 4, v13
  v_mad_u32_u24 v4, v9, s62, v12
  s_mul_i32 s64, s56, 24576
  s_add_u32 s64, s64, s69
  s_mov_b32 s87, 10731520
  s_load_dword s73, s[28:29], s87
  s_mov_b32 s74, 0x3f803f80
  s_mov_b32 s75, 0x00003f80
  s_mov_b32 s76, 0x3f800000
  s_mov_b32 s40, s28
  s_mov_b32 s41, s29
  s_mov_b32 s42, 14155776
  s_mov_b32 s43, 0x20000
  v_and_b32 v14, 3, v1
  v_and_b32 v22, 1, v9
  v_lshlrev_b32 v26, 12, v22
  v_lshlrev_b32 v25, 2, v22
  v_xor_b32 v25, v25, v8
  v_lshlrev_b32 v59, 4, v25
  v_mov_b32 v60, v10
  v_lshl_add_u32 v7, v10, 10, v59
  v_lshlrev_b32 v22, 5, v22
  v_lshl_add_u32 v22, v14, 3, v22
  v_bfe_u32 v23, v1, 2, 2
  v_xor_b32 v25, 0, v23
  v_lshlrev_b32 v27, 12, v24
  v_lshl_add_u32 v27, v23, 8, v27
  v_add_u32 v27, v27, v22
  v_add_u32 v27, 2048, v27
  v_lshl_add_u32 v28, v25, 6, v27
  v_and_b32 v46, 1, v9
  v_lshrrev_b32 v47, 1, v9
  v_lshl_add_u32 v46, v46, 1, v47
  v_lshl_add_u32 v46, v8, 3, v46
  s_lshl_b32 s86, s56, 8
  s_add_u32 s86, s86, 159744
  v_lshl_add_u32 v46, v46, 2, s86
  v_and_b32 v27, 15, v1
  v_lshl_add_u32 v26, v27, 7, v26
  s_lshl_b32 s86, s60, 13
  v_add_u32 v26, s86, v26
  v_bfe_u32 v27, v1, 1, 3
  v_xor_b32 v27, v27, v24
  v_lshl_add_u32 v29, v27, 4, v26
  s_and_b32 s86, s2, 6
  s_lshr_b32 s87, s2, 3
  s_lshl_b32 s66, s86, 1
  s_and_b32 s86, s87, 3
  s_add_u32 s66, s66, s86
  s_bfe_u32 s67, s87, 0x10002
  s_lshr_b32 s68, s87, 3
  s_and_b32 s86, s2, 1
  s_lshl_b32 s86, s86, 2
  s_add_u32 s68, s68, s86
  s_lshl_b32 s70, s58, 7
  v_mad_u32_u24 v5, v60, s62, v59
  v_lshl_add_u32 v56, v24, 3, v23
  v_lshl_add_u32 v56, v56, 7, v22
  v_lshrrev_b32 v57, 1, v23
  v_lshl_add_u32 v14, v57, 6, v56
  s_lshl_b32 s86, s57, 2
  s_add_u32 s86, s86, s60
  s_mul_i32 s77, s86, 147456
  s_lshr_b32 s86, s86, 1
  s_lshl_b32 s86, s86, 3
  s_lshr_b32 s87, s58, 1
  s_add_u32 s86, s86, s87
  s_lshl_b32 s86, s86, 7
  s_and_b32 s87, s58, 1
  s_lshl_b32 s87, s87, 4
  s_add_u32 s86, s86, s87
  s_and_b32 s87, s60, 1
  s_lshl_b32 s87, s87, 3
  s_add_u32 s86, s86, s87
  s_add_u32 m0, s65, 2048
  s_add_u32 s80, s86, 10698752
  buffer_load_dwordx4 v4, s[36:39], s64 offen lds
  s_add_u32 m0, s65, 0
  s_nop 0
  buffer_load_dwordx4 v2, s[32:35], s63 offen lds
  s_add_u32 m0, s65, 3072
  s_add_u32 s64, s64, s3
  buffer_load_dwordx4 v4, s[36:39], s64 offen lds
  s_add_u32 m0, s65, 1024
  s_nop 0
  buffer_load_dwordx4 v3, s[32:35], s63 offen lds
  s_mov_b32 s4, 159744
  s_lshl_b32 s65, s60, 13
  s_lshl_b32 s63, s57, 2
  s_add_u32 s63, s63, s60
  s_lshl_b32 s63, s63, 15
  s_add_u32 s7, s63, 16384
  s_mul_i32 s64, s60, 49152
  s_add_u32 s64, s64, s69
  s_add_u32 s64, s64, 36864
  v_and_b32 v96, 31, v1
  s_lshl_b32 s86, s60, 5
  s_add_u32 s86, s86, 16
  v_add_u32 v96, s86, v96
  v_mul_u32_u24 v96, 144, v96
  v_lshl_add_u32 v96, v24, 5, v96
  v_add_u32 v96, 65536, v96
  s_lshl_b32 s87, s57, 3
  s_add_u32 s87, s87, s58
  s_lshl_b32 s72, s87, 13
  s_add_u32 s72, s72, 10747904
  s_lshl_b32 s83, s87, 7
  s_add_u32 s83, s83, 10682368
  v_and_b32 v97, 15, v1
  v_mul_u32_u24 v97, 144, v97
  v_lshl_add_u32 v97, v24, 5, v97
  v_and_b32 v98, 16, v1
  v_cmp_ne_u32 vcc, 0, v98
  v_mov_b32 v98, 2146435072
  s_cmp_eq_u32 s60, 3
  s_cselect_b32 s72, s72, 2146435072
  s_cselect_b32 s83, s83, 2146435072
  v_cndmask_b32 v97, v98, v97, vcc
  v_mov_b32 v12, v28
  v_xor_b32 v13, 64, v28
  v_mov_b32 v8, v29
  v_xor_b32 v9, 32, v29
  v_xor_b32 v10, 64, v29
  v_xor_b32 v11, 96, v29
  s_waitcnt vmcnt(6)
  v_dot2_f32_bf16 v44, v32, s74, 0
  v_dot2_f32_bf16 v45, v32, v32, 0
  v_dot2_f32_bf16 v44, v33, s74, v44
  v_dot2_f32_bf16 v45, v33, v33, v45
  v_dot2_f32_bf16 v44, v34, s74, v44
  v_dot2_f32_bf16 v45, v34, v34, v45
  v_dot2_f32_bf16 v44, v35, s74, v44
  v_dot2_f32_bf16 v45, v35, v35, v45
  s_waitcnt vmcnt(4)
  v_dot2_f32_bf16 v48, v36, s75, 0
  v_dot2_f32_bf16 v49, v36, s76, 0
  v_dot2_f32_bf16 v50, v37, s75, 0
  v_dot2_f32_bf16 v51, v37, s76, 0
  v_dot2_f32_bf16 v52, v38, s75, 0
  v_dot2_f32_bf16 v53, v38, s76, 0
  v_dot2_f32_bf16 v54, v39, s75, 0
  v_dot2_f32_bf16 v55, v39, s76, 0
  v_dot2_f32_bf16 v48, v40, s75, v48
  v_dot2_f32_bf16 v49, v40, s76, v49
  v_dot2_f32_bf16 v50, v41, s75, v50
  v_dot2_f32_bf16 v51, v41, s76, v51
  v_dot2_f32_bf16 v52, v42, s75, v52
  v_dot2_f32_bf16 v53, v42, s76, v53
  v_dot2_f32_bf16 v54, v43, s75, v54
  v_dot2_f32_bf16 v55, v43, s76, v55
  v_permlane32_swap_b32 v44, v45
  v_permlane32_swap_b32 v48, v49
  v_permlane32_swap_b32 v50, v51
  v_permlane32_swap_b32 v52, v53
  v_permlane32_swap_b32 v54, v55
  v_add_f32 v56, v44, v45
  v_add_f32 v48, v48, v49
  v_add_f32 v50, v50, v51
  v_add_f32 v52, v52, v53
  v_add_f32 v54, v54, v55
  v_mov_b32 v57, v56
  v_permlane16_swap_b32 v48, v50
  v_permlane16_swap_b32 v52, v54
  v_add_f32 v48, v48, v50
  v_add_f32 v52, v52, v54
  v_permlane16_swap_b32 v56, v57
  v_add_f32_dpp v48, v48, v48 row_ror:8 row_mask:0xf bank_mask:0xf
  v_add_f32_dpp v52, v52, v52 row_ror:8 row_mask:0xf bank_mask:0xf
  v_add_f32 v56, v56, v57
  ds_write2_b32 v46, v48, v52 offset0:0 offset1:4
  s_waitcnt lgkmcnt(0)
  s_mul_i32 s59, s73, 0x9E3779B1
  s_add_u32 s59, s59, 0x7F4A7C15
  s_and_b32 s59, s59, 0xfffffffc
  s_barrier
  v_add_f32_dpp v56, v56, v56 row_ror:8 row_mask:0xf bank_mask:0xf
  s_nop 1
  v_add_f32_dpp v56, v56, v56 row_ror:4 row_mask:0xf bank_mask:0xf
  s_lshl_b32 s88, s98, 3
  s_nop 0
  v_add_f32_dpp v56, v56, v56 row_ror:2 row_mask:0xf bank_mask:0xf
  s_add_u32 s88, s88, 10485760
  v_mov_b32 v117, s59
  v_add_f32_dpp v56, v56, v56 row_ror:1 row_mask:0xf bank_mask:0xf
  v_mov_b32 v112, 0x3b000000
  v_readlane_b32 s86, v56, 0
  v_readlane_b32 s87, v56, 32
  s_nop 0
  v_mul_f32 v113, s86, v112
  v_mul_f32 v114, s87, v112
  v_fma_f32 v114, -v113, v113, v114
  v_max_f32 v114, 0, v114
  v_cvt_pk_bf16_f32 v115, v113, v114
  v_and_b32 v115, 0xffff0000, v115
  v_add_f32 v115, 0x3727c5ac, v115
  v_cvt_pk_bf16_f32 v115, v115, v115
  v_and_b32 v115, 0xffff0000, v115
  v_sqrt_f32 v115, v115
  s_nop 0
  v_cvt_pk_bf16_f32 v116, v113, v115
  s_mov_b32 s98, s88
  s_add_u32 m0, s65, 34816
  s_add_u32 s64, s64, s4
  buffer_load_dwordx4 v4, s[36:39], s64 offen lds
  s_add_u32 m0, s65, 32768
  s_add_u32 s63, s63, 128
  buffer_load_dwordx4 v2, s[32:35], s63 offen lds
  s_add_u32 m0, s65, 35840
  s_add_u32 s64, s64, s3
  buffer_load_dwordx4 v4, s[36:39], s64 offen lds
  s_add_u32 m0, s65, 33792
  s_add_u32 s7, s7, 128
  buffer_load_dwordx4 v3, s[32:35], s63 offen lds
  s_add_u32 m0, s65, 38912
  s_add_u32 s64, s64, s3
  buffer_load_dwordx4 v4, s[36:39], s64 offen lds
  s_add_u32 m0, s65, 36864
  s_nop 0
  buffer_load_dwordx4 v2, s[32:35], s7 offen lds
  s_add_u32 m0, s65, 39936
  s_add_u32 s64, s64, s3
  buffer_load_dwordx4 v4, s[36:39], s64 offen lds
  s_add_u32 m0, s65, 37888
  s_nop 0
  buffer_load_dwordx4 v3, s[32:35], s7 offen lds
  s_add_u32 m0, s65, 67584
  s_add_u32 s64, s64, s4
  buffer_load_dwordx4 v4, s[36:39], s64 offen lds
  s_add_u32 m0, s65, 65536
  s_add_u32 s63, s63, 128
  buffer_load_dwordx4 v2, s[32:35], s63 offen lds
  s_add_u32 m0, s65, 68608
  s_add_u32 s64, s64, s3
  buffer_load_dwordx4 v4, s[36:39], s64 offen lds
  s_add_u32 m0, s65, 66560
  s_add_u32 s7, s7, 128
  buffer_load_dwordx4 v3, s[32:35], s63 offen lds
  s_add_u32 m0, s65, 71680
  s_add_u32 s64, s64, s3
  buffer_load_dwordx4 v4, s[36:39], s64 offen lds
  s_add_u32 m0, s65, 69632
  s_nop 0
  buffer_load_dwordx4 v2, s[32:35], s7 offen lds
  s_add_u32 m0, s65, 72704
  s_add_u32 s64, s64, s3
  buffer_load_dwordx4 v4, s[36:39], s64 offen lds
  s_add_u32 m0, s65, 70656
  s_nop 0
  buffer_load_dwordx4 v3, s[32:35], s7 offen lds
  s_waitcnt vmcnt(16)
  s_barrier
  ds_read_b64_tr_b16 v[32:33], v12 offset:0
  ds_read_b64_tr_b16 v[34:35], v12 offset:1024
  ds_read_b128 v[128:131], v8 offset:0
  ds_read_b64_tr_b16 v[36:37], v13 offset:0
  ds_read_b64_tr_b16 v[38:39], v13 offset:1024
  s_waitcnt lgkmcnt(0)
  v_mfma_f32_32x32x16_bf16 v[64:79], v[32:35], v[128:131], 0
  s_add_u32 m0, s65, 100352
  s_add_u32 s64, s64, s4
  buffer_load_dwordx4 v4, s[36:39], s64 offen lds
  ds_read_b64_tr_b16 v[40:41], v12 offset:8192
  ds_read_b64_tr_b16 v[42:43], v12 offset:9216
  ds_read_b128 v[132:135], v9 offset:0
  ds_read_b64_tr_b16 v[44:45], v13 offset:8192
  ds_read_b64_tr_b16 v[46:47], v13 offset:9216
  v_mfma_f32_32x32x16_bf16 v[80:95], v[36:39], v[128:131], 0
  s_add_u32 m0, s65, 98304
  s_add_u32 s63, s63, 128
  buffer_load_dwordx4 v2, s[32:35], s63 offen lds
  s_mov_b64 exec, 1
  buffer_store_dwordx2 v[116:117], off, s[40:43], s98 sc1
  s_mov_b64 exec, -1
  s_waitcnt lgkmcnt(0)
  v_mfma_f32_32x32x16_bf16 v[64:79], v[40:43], v[132:135], v[64:79]
  s_add_u32 m0, s65, 101376
  s_add_u32 s64, s64, s3
  buffer_load_dwordx4 v4, s[36:39], s64 offen lds
  ds_read_b64_tr_b16 v[32:33], v12 offset:16384
  ds_read_b64_tr_b16 v[34:35], v12 offset:17408
  ds_read_b128 v[136:139], v10 offset:0
  ds_read_b64_tr_b16 v[36:37], v13 offset:16384
  ds_read_b64_tr_b16 v[38:39], v13 offset:17408
  v_mfma_f32_32x32x16_bf16 v[80:95], v[44:47], v[132:135], v[80:95]
  s_add_u32 m0, s65, 99328
  s_add_u32 s7, s7, 128
  buffer_load_dwordx4 v3, s[32:35], s63 offen lds
  s_waitcnt lgkmcnt(0)
  v_mfma_f32_32x32x16_bf16 v[64:79], v[32:35], v[136:139], v[64:79]
  s_add_u32 m0, s65, 104448
  s_add_u32 s64, s64, s3
  buffer_load_dwordx4 v4, s[36:39], s64 offen lds
  ds_read_b64_tr_b16 v[40:41], v12 offset:24576
  ds_read_b64_tr_b16 v[42:43], v12 offset:25600
  ds_read_b128 v[140:143], v11 offset:0
  ds_read_b64_tr_b16 v[44:45], v13 offset:24576
  ds_read_b64_tr_b16 v[46:47], v13 offset:25600
  v_mfma_f32_32x32x16_bf16 v[80:95], v[36:39], v[136:139], v[80:95]
  s_add_u32 m0, s65, 102400
  s_nop 0
  buffer_load_dwordx4 v2, s[32:35], s7 offen lds
  s_waitcnt vmcnt(15)
  s_barrier
  s_waitcnt lgkmcnt(0)
  v_mfma_f32_32x32x16_bf16 v[64:79], v[40:43], v[140:143], v[64:79]
  s_add_u32 m0, s65, 105472
  s_add_u32 s64, s64, s3
  buffer_load_dwordx4 v4, s[36:39], s64 offen lds
  ds_read_b64_tr_b16 v[32:33], v12 offset:32768
  ds_read_b64_tr_b16 v[34:35], v12 offset:33792
  ds_read_b128 v[144:147], v8 offset:32768
  ds_read_b64_tr_b16 v[36:37], v13 offset:32768
  ds_read_b64_tr_b16 v[38:39], v13 offset:33792
  v_mfma_f32_32x32x16_bf16 v[80:95], v[44:47], v[140:143], v[80:95]
  s_add_u32 m0, s65, 103424
  s_nop 0
  buffer_load_dwordx4 v3, s[32:35], s7 offen lds
  s_waitcnt lgkmcnt(0)
  v_mfma_f32_32x32x16_bf16 v[64:79], v[32:35], v[144:147], v[64:79]
  ds_read_b64_tr_b16 v[40:41], v12 offset:40960
  ds_read_b64_tr_b16 v[42:43], v12 offset:41984
  ds_read_b128 v[148:151], v9 offset:32768
  ds_read_b64_tr_b16 v[44:45], v13 offset:40960
  ds_read_b64_tr_b16 v[46:47], v13 offset:41984
  v_mfma_f32_32x32x16_bf16 v[80:95], v[36:39], v[144:147], v[80:95]
  s_waitcnt lgkmcnt(0)
  v_mfma_f32_32x32x16_bf16 v[64:79], v[40:43], v[148:151], v[64:79]
  ds_read_b64_tr_b16 v[32:33], v12 offset:49152
  ds_read_b64_tr_b16 v[34:35], v12 offset:50176
  ds_read_b128 v[152:155], v10 offset:32768
  ds_read_b64_tr_b16 v[36:37], v13 offset:49152
  ds_read_b64_tr_b16 v[38:39], v13 offset:50176
  v_mfma_f32_32x32x16_bf16 v[80:95], v[44:47], v[148:151], v[80:95]
  s_waitcnt lgkmcnt(0)
  v_mfma_f32_32x32x16_bf16 v[64:79], v[32:35], v[152:155], v[64:79]
  ds_read_b64_tr_b16 v[40:41], v12 offset:57344
  ds_read_b64_tr_b16 v[42:43], v12 offset:58368
  ds_read_b128 v[156:159], v11 offset:32768
  ds_read_b64_tr_b16 v[44:45], v13 offset:57344
  ds_read_b64_tr_b16 v[46:47], v13 offset:58368
  v_mfma_f32_32x32x16_bf16 v[80:95], v[36:39], v[152:155], v[80:95]
  s_waitcnt vmcnt(9)
  s_barrier
  s_waitcnt lgkmcnt(0)
  v_mfma_f32_32x32x16_bf16 v[64:79], v[40:43], v[156:159], v[64:79]
  s_add_u32 m0, s65, 2048
  s_add_u32 s64, s64, s4
  buffer_load_dwordx4 v4, s[36:39], s64 offen lds
  s_add_u32 m0, s65, 0
  s_add_u32 s63, s63, 128
  buffer_load_dwordx4 v2, s[32:35], s63 offen lds
  v_xor_b32 v8, 0x10000, v8
  v_xor_b32 v9, 0x10000, v9
  v_xor_b32 v10, 0x10000, v10
  v_xor_b32 v11, 0x10000, v11
  v_xor_b32 v12, 0x10000, v12
  v_xor_b32 v13, 0x10000, v13
  ds_read_b64_tr_b16 v[32:33], v12 offset:0
  ds_read_b64_tr_b16 v[34:35], v12 offset:1024
  ds_read_b128 v[160:163], v8 offset:0
  ds_read_b64_tr_b16 v[36:37], v13 offset:0
  ds_read_b64_tr_b16 v[38:39], v13 offset:1024
  v_mfma_f32_32x32x16_bf16 v[80:95], v[44:47], v[156:159], v[80:95]
  s_add_u32 m0, s65, 3072
  s_add_u32 s64, s64, s3
  buffer_load_dwordx4 v4, s[36:39], s64 offen lds
  s_add_u32 m0, s65, 1024
  s_add_u32 s7, s7, 128
  buffer_load_dwordx4 v3, s[32:35], s63 offen lds
  s_waitcnt lgkmcnt(0)
  v_mfma_f32_32x32x16_bf16 v[64:79], v[32:35], v[160:163], v[64:79]
  s_add_u32 m0, s65, 6144
  s_add_u32 s64, s64, s3
  buffer_load_dwordx4 v4, s[36:39], s64 offen lds
  s_add_u32 m0, s65, 4096
  s_nop 0
  buffer_load_dwordx4 v2, s[32:35], s7 offen lds
  ds_read_b64_tr_b16 v[40:41], v12 offset:8192
  ds_read_b64_tr_b16 v[42:43], v12 offset:9216
  ds_read_b128 v[164:167], v9 offset:0
  ds_read_b64_tr_b16 v[44:45], v13 offset:8192
  ds_read_b64_tr_b16 v[46:47], v13 offset:9216
  v_mfma_f32_32x32x16_bf16 v[80:95], v[36:39], v[160:163], v[80:95]
  s_add_u32 m0, s65, 7168
  s_add_u32 s64, s64, s3
  buffer_load_dwordx4 v4, s[36:39], s64 offen lds
  s_add_u32 m0, s65, 5120
  s_nop 0
  buffer_load_dwordx4 v3, s[32:35], s7 offen lds
  s_waitcnt lgkmcnt(0)
  v_mfma_f32_32x32x16_bf16 v[64:79], v[40:43], v[164:167], v[64:79]
  ds_read_b64_tr_b16 v[32:33], v12 offset:16384
  ds_read_b64_tr_b16 v[34:35], v12 offset:17408
  ds_read_b128 v[168:171], v10 offset:0
  ds_read_b64_tr_b16 v[36:37], v13 offset:16384
  ds_read_b64_tr_b16 v[38:39], v13 offset:17408
  v_mfma_f32_32x32x16_bf16 v[80:95], v[44:47], v[164:167], v[80:95]
  s_waitcnt lgkmcnt(0)
  v_mfma_f32_32x32x16_bf16 v[64:79], v[32:35], v[168:171], v[64:79]
  ds_read_b64_tr_b16 v[40:41], v12 offset:24576
  ds_read_b64_tr_b16 v[42:43], v12 offset:25600
  ds_read_b128 v[172:175], v11 offset:0
  ds_read_b64_tr_b16 v[44:45], v13 offset:24576
  ds_read_b64_tr_b16 v[46:47], v13 offset:25600
  v_mfma_f32_32x32x16_bf16 v[80:95], v[36:39], v[168:171], v[80:95]
  s_waitcnt vmcnt(8)
  s_barrier
  s_waitcnt lgkmcnt(0)
  v_mfma_f32_32x32x16_bf16 v[64:79], v[40:43], v[172:175], v[64:79]
  s_add_u32 m0, s65, 34816
  s_add_u32 s64, s64, s4
  buffer_load_dwordx4 v4, s[36:39], s64 offen lds
  s_add_u32 m0, s65, 32768
  s_add_u32 s63, s63, 128
  buffer_load_dwordx4 v2, s[32:35], s63 offen lds
  ds_read_b64_tr_b16 v[32:33], v12 offset:32768
  ds_read_b64_tr_b16 v[34:35], v12 offset:33792
  ds_read_b128 v[176:179], v8 offset:32768
  ds_read_b64_tr_b16 v[36:37], v13 offset:32768
  ds_read_b64_tr_b16 v[38:39], v13 offset:33792
  v_mfma_f32_32x32x16_bf16 v[80:95], v[44:47], v[172:175], v[80:95]
  s_add_u32 m0, s65, 35840
  s_add_u32 s64, s64, s3
  buffer_load_dwordx4 v4, s[36:39], s64 offen lds
  s_add_u32 m0, s65, 33792
  s_add_u32 s7, s7, 128
  buffer_load_dwordx4 v3, s[32:35], s63 offen lds
  s_waitcnt lgkmcnt(0)
  v_mfma_f32_32x32x16_bf16 v[64:79], v[32:35], v[176:179], v[64:79]
  s_add_u32 m0, s65, 38912
  s_add_u32 s64, s64, s3
  buffer_load_dwordx4 v4, s[36:39], s64 offen lds
  s_add_u32 m0, s65, 36864
  s_nop 0
  buffer_load_dwordx4 v2, s[32:35], s7 offen lds
  ds_read_b64_tr_b16 v[40:41], v12 offset:40960
  ds_read_b64_tr_b16 v[42:43], v12 offset:41984
  ds_read_b128 v[180:183], v9 offset:32768
  ds_read_b64_tr_b16 v[44:45], v13 offset:40960
  ds_read_b64_tr_b16 v[46:47], v13 offset:41984
  v_mfma_f32_32x32x16_bf16 v[80:95], v[36:39], v[176:179], v[80:95]
  s_add_u32 m0, s65, 39936
  s_add_u32 s64, s64, s3
  buffer_load_dwordx4 v4, s[36:39], s64 offen lds
  s_add_u32 m0, s65, 37888
  s_nop 0
  buffer_load_dwordx4 v3, s[32:35], s7 offen lds
  s_waitcnt lgkmcnt(0)
  v_mfma_f32_32x32x16_bf16 v[64:79], v[40:43], v[180:183], v[64:79]
  ds_read_b64_tr_b16 v[32:33], v12 offset:49152
  ds_read_b64_tr_b16 v[34:35], v12 offset:50176
  ds_read_b128 v[184:187], v10 offset:32768
  ds_read_b64_tr_b16 v[36:37], v13 offset:49152
  ds_read_b64_tr_b16 v[38:39], v13 offset:50176
  v_mfma_f32_32x32x16_bf16 v[80:95], v[44:47], v[180:183], v[80:95]
  s_waitcnt lgkmcnt(0)
  v_mfma_f32_32x32x16_bf16 v[64:79], v[32:35], v[184:187], v[64:79]
  ds_read_b64_tr_b16 v[40:41], v12 offset:57344
  ds_read_b64_tr_b16 v[42:43], v12 offset:58368
  ds_read_b128 v[188:191], v11 offset:32768
  ds_read_b64_tr_b16 v[44:45], v13 offset:57344
  ds_read_b64_tr_b16 v[46:47], v13 offset:58368
  v_mfma_f32_32x32x16_bf16 v[80:95], v[36:39], v[184:187], v[80:95]
  s_waitcnt vmcnt(8)
  s_barrier
  s_waitcnt lgkmcnt(0)
  v_mfma_f32_32x32x16_bf16 v[64:79], v[40:43], v[188:191], v[64:79]
  s_add_u32 m0, s65, 67584
  s_add_u32 s64, s64, s4
  buffer_load_dwordx4 v4, s[36:39], s64 offen lds
  s_add_u32 m0, s65, 65536
  s_add_u32 s63, s63, 128
  buffer_load_dwordx4 v2, s[32:35], s63 offen lds
  v_xor_b32 v8, 0x10000, v8
  v_xor_b32 v9, 0x10000, v9
  v_xor_b32 v10, 0x10000, v10
  v_xor_b32 v11, 0x10000, v11
  v_xor_b32 v12, 0x10000, v12
  v_xor_b32 v13, 0x10000, v13
  ds_read_b64_tr_b16 v[32:33], v12 offset:0
  ds_read_b64_tr_b16 v[34:35], v12 offset:1024
  ds_read_b128 v[192:195], v8 offset:0
  ds_read_b64_tr_b16 v[36:37], v13 offset:0
  ds_read_b64_tr_b16 v[38:39], v13 offset:1024
  v_mfma_f32_32x32x16_bf16 v[80:95], v[44:47], v[188:191], v[80:95]
  s_add_u32 m0, s65, 68608
  s_add_u32 s64, s64, s3
  buffer_load_dwordx4 v4, s[36:39], s64 offen lds
  s_add_u32 m0, s65, 66560
  s_add_u32 s7, s7, 128
  buffer_load_dwordx4 v3, s[32:35], s63 offen lds
  s_waitcnt lgkmcnt(0)
  v_mfma_f32_32x32x16_bf16 v[64:79], v[32:35], v[192:195], v[64:79]
  s_add_u32 m0, s65, 71680
  s_add_u32 s64, s64, s3
  buffer_load_dwordx4 v4, s[36:39], s64 offen lds
  s_add_u32 m0, s65, 69632
  s_nop 0
  buffer_load_dwordx4 v2, s[32:35], s7 offen lds
  ds_read_b64_tr_b16 v[40:41], v12 offset:8192
  ds_read_b64_tr_b16 v[42:43], v12 offset:9216
  ds_read_b128 v[196:199], v9 offset:0
  ds_read_b64_tr_b16 v[44:45], v13 offset:8192
  ds_read_b64_tr_b16 v[46:47], v13 offset:9216
  v_mfma_f32_32x32x16_bf16 v[80:95], v[36:39], v[192:195], v[80:95]
  s_add_u32 m0, s65, 72704
  s_add_u32 s64, s64, s3
  buffer_load_dwordx4 v4, s[36:39], s64 offen lds
  s_add_u32 m0, s65, 70656
  s_nop 0
  buffer_load_dwordx4 v3, s[32:35], s7 offen lds
  s_waitcnt lgkmcnt(0)
  v_mfma_f32_32x32x16_bf16 v[64:79], v[40:43], v[196:199], v[64:79]
  ds_read_b64_tr_b16 v[32:33], v12 offset:16384
  ds_read_b64_tr_b16 v[34:35], v12 offset:17408
  ds_read_b128 v[200:203], v10 offset:0
  ds_read_b64_tr_b16 v[36:37], v13 offset:16384
  ds_read_b64_tr_b16 v[38:39], v13 offset:17408
  v_mfma_f32_32x32x16_bf16 v[80:95], v[44:47], v[196:199], v[80:95]
  s_waitcnt lgkmcnt(0)
  v_mfma_f32_32x32x16_bf16 v[64:79], v[32:35], v[200:203], v[64:79]
  ds_read_b64_tr_b16 v[40:41], v12 offset:24576
  ds_read_b64_tr_b16 v[42:43], v12 offset:25600
  ds_read_b128 v[204:207], v11 offset:0
  ds_read_b64_tr_b16 v[44:45], v13 offset:24576
  ds_read_b64_tr_b16 v[46:47], v13 offset:25600
  v_mfma_f32_32x32x16_bf16 v[80:95], v[36:39], v[200:203], v[80:95]
  s_waitcnt vmcnt(8)
  s_barrier
  s_waitcnt lgkmcnt(0)
  v_mfma_f32_32x32x16_bf16 v[64:79], v[40:43], v[204:207], v[64:79]
  s_add_u32 m0, s65, 100352
  s_add_u32 s64, s64, s4
  buffer_load_dwordx4 v4, s[36:39], s64 offen lds
  s_add_u32 m0, s65, 98304
  s_add_u32 s63, s63, 128
  buffer_load_dwordx4 v2, s[32:35], s63 offen lds
  ds_read_b64_tr_b16 v[32:33], v12 offset:32768
  ds_read_b64_tr_b16 v[34:35], v12 offset:33792
  ds_read_b128 v[208:211], v8 offset:32768
  ds_read_b64_tr_b16 v[36:37], v13 offset:32768
  ds_read_b64_tr_b16 v[38:39], v13 offset:33792
  v_mfma_f32_32x32x16_bf16 v[80:95], v[44:47], v[204:207], v[80:95]
  s_add_u32 m0, s65, 101376
  s_add_u32 s64, s64, s3
  buffer_load_dwordx4 v4, s[36:39], s64 offen lds
  s_add_u32 m0, s65, 99328
  s_add_u32 s7, s7, 128
  buffer_load_dwordx4 v3, s[32:35], s63 offen lds
  s_waitcnt lgkmcnt(0)
  v_mfma_f32_32x32x16_bf16 v[64:79], v[32:35], v[208:211], v[64:79]
  s_add_u32 m0, s65, 104448
  s_add_u32 s64, s64, s3
  buffer_load_dwordx4 v4, s[36:39], s64 offen lds
  s_add_u32 m0, s65, 102400
  s_nop 0
  buffer_load_dwordx4 v2, s[32:35], s7 offen lds
  ds_read_b64_tr_b16 v[40:41], v12 offset:40960
  ds_read_b64_tr_b16 v[42:43], v12 offset:41984
  ds_read_b128 v[212:215], v9 offset:32768
  ds_read_b64_tr_b16 v[44:45], v13 offset:40960
  ds_read_b64_tr_b16 v[46:47], v13 offset:41984
  v_mfma_f32_32x32x16_bf16 v[80:95], v[36:39], v[208:211], v[80:95]
  s_add_u32 m0, s65, 105472
  s_add_u32 s64, s64, s3
  buffer_load_dwordx4 v4, s[36:39], s64 offen lds
  s_add_u32 m0, s65, 103424
  s_nop 0
  buffer_load_dwordx4 v3, s[32:35], s7 offen lds
  s_waitcnt lgkmcnt(0)
  v_mfma_f32_32x32x16_bf16 v[64:79], v[40:43], v[212:215], v[64:79]
  ds_read_b64_tr_b16 v[32:33], v12 offset:49152
  ds_read_b64_tr_b16 v[34:35], v12 offset:50176
  ds_read_b128 v[216:219], v10 offset:32768
  ds_read_b64_tr_b16 v[36:37], v13 offset:49152
  ds_read_b64_tr_b16 v[38:39], v13 offset:50176
  v_mfma_f32_32x32x16_bf16 v[80:95], v[44:47], v[212:215], v[80:95]
  s_waitcnt lgkmcnt(0)
  v_mfma_f32_32x32x16_bf16 v[64:79], v[32:35], v[216:219], v[64:79]
  ds_read_b64_tr_b16 v[40:41], v12 offset:57344
  ds_read_b64_tr_b16 v[42:43], v12 offset:58368
  ds_read_b128 v[220:223], v11 offset:32768
  ds_read_b64_tr_b16 v[44:45], v13 offset:57344
  ds_read_b64_tr_b16 v[46:47], v13 offset:58368
  v_mfma_f32_32x32x16_bf16 v[80:95], v[36:39], v[216:219], v[80:95]
  s_waitcnt vmcnt(8)
  s_barrier
  s_waitcnt lgkmcnt(0)
  v_mfma_f32_32x32x16_bf16 v[64:79], v[40:43], v[220:223], v[64:79]
  s_add_u32 s5, s60, 0
  s_add_u32 s5, s5, 0
  s_and_b32 s5, s5, 7
  s_lshl_b32 s5, s5, 6
  s_mul_i32 s5, s5, s62
  s_add_u32 s5, s5, s70
  s_add_u32 m0, s65, 0
  s_lshl_b32 s7, s62, 3
  buffer_load_dwordx4 v5, s[36:39], s5 offen lds
  s_add_u32 m0, s65, 1024
  s_add_u32 s5, s5, s7
  buffer_load_dwordx4 v5, s[36:39], s5 offen lds
  v_xor_b32 v8, 0x10000, v8
  v_xor_b32 v9, 0x10000, v9
  v_xor_b32 v10, 0x10000, v10
  v_xor_b32 v11, 0x10000, v11
  v_xor_b32 v12, 0x10000, v12
  v_xor_b32 v13, 0x10000, v13
  ds_read_b64_tr_b16 v[32:33], v12 offset:0
  ds_read_b64_tr_b16 v[34:35], v12 offset:1024
  ds_read_b128 v[224:227], v8 offset:0
  ds_read_b64_tr_b16 v[36:37], v13 offset:0
  ds_read_b64_tr_b16 v[38:39], v13 offset:1024
  v_mfma_f32_32x32x16_bf16 v[80:95], v[44:47], v[220:223], v[80:95]
  s_add_u32 m0, s65, 2048
  s_add_u32 s5, s5, s7
  buffer_load_dwordx4 v5, s[36:39], s5 offen lds
  s_add_u32 m0, s65, 3072
  s_add_u32 s5, s5, s7
  buffer_load_dwordx4 v5, s[36:39], s5 offen lds
  s_waitcnt lgkmcnt(0)
  v_mfma_f32_32x32x16_bf16 v[64:79], v[32:35], v[224:227], v[64:79]
  s_add_u32 m0, s65, 4096
  s_add_u32 s5, s5, s7
  buffer_load_dwordx4 v5, s[36:39], s5 offen lds
  s_add_u32 m0, s65, 5120
  s_add_u32 s5, s5, s7
  buffer_load_dwordx4 v5, s[36:39], s5 offen lds
  ds_read_b64_tr_b16 v[40:41], v12 offset:8192
  ds_read_b64_tr_b16 v[42:43], v12 offset:9216
  ds_read_b128 v[228:231], v9 offset:0
  ds_read_b64_tr_b16 v[44:45], v13 offset:8192
  ds_read_b64_tr_b16 v[46:47], v13 offset:9216
  v_mfma_f32_32x32x16_bf16 v[80:95], v[36:39], v[224:227], v[80:95]
  s_add_u32 m0, s65, 6144
  s_add_u32 s5, s5, s7
  buffer_load_dwordx4 v5, s[36:39], s5 offen lds
  s_add_u32 m0, s65, 7168
  s_add_u32 s5, s5, s7
  buffer_load_dwordx4 v5, s[36:39], s5 offen lds
  s_waitcnt lgkmcnt(0)
  v_mfma_f32_32x32x16_bf16 v[64:79], v[40:43], v[228:231], v[64:79]
  ds_read_b64_tr_b16 v[32:33], v12 offset:16384
  ds_read_b64_tr_b16 v[34:35], v12 offset:17408
  ds_read_b128 v[232:235], v10 offset:0
  ds_read_b64_tr_b16 v[36:37], v13 offset:16384
  ds_read_b64_tr_b16 v[38:39], v13 offset:17408
  v_mfma_f32_32x32x16_bf16 v[80:95], v[44:47], v[228:231], v[80:95]
  s_waitcnt lgkmcnt(0)
  v_mfma_f32_32x32x16_bf16 v[64:79], v[32:35], v[232:235], v[64:79]
  ds_read_b64_tr_b16 v[40:41], v12 offset:24576
  ds_read_b64_tr_b16 v[42:43], v12 offset:25600
  ds_read_b128 v[236:239], v11 offset:0
  ds_read_b64_tr_b16 v[44:45], v13 offset:24576
  ds_read_b64_tr_b16 v[46:47], v13 offset:25600
  v_mfma_f32_32x32x16_bf16 v[80:95], v[36:39], v[232:235], v[80:95]
  s_waitcnt vmcnt(8)
  s_barrier
  s_waitcnt lgkmcnt(0)
  v_mfma_f32_32x32x16_bf16 v[64:79], v[40:43], v[236:239], v[64:79]
  s_add_u32 s5, s60, 4
  s_add_u32 s5, s5, 0
  s_and_b32 s5, s5, 7
  s_lshl_b32 s5, s5, 6
  s_mul_i32 s5, s5, s62
  s_add_u32 s5, s5, s70
  s_add_u32 m0, s65, 32768
  s_lshl_b32 s7, s62, 3
  buffer_load_dwordx4 v5, s[36:39], s5 offen lds
  s_add_u32 m0, s65, 33792
  s_add_u32 s5, s5, s7
  buffer_load_dwordx4 v5, s[36:39], s5 offen lds
  ds_read_b64_tr_b16 v[32:33], v12 offset:32768
  ds_read_b64_tr_b16 v[34:35], v12 offset:33792
  ds_read_b128 v[240:243], v8 offset:32768
  ds_read_b64_tr_b16 v[36:37], v13 offset:32768
  ds_read_b64_tr_b16 v[38:39], v13 offset:33792
  v_mfma_f32_32x32x16_bf16 v[80:95], v[44:47], v[236:239], v[80:95]
  s_add_u32 m0, s65, 34816
  s_add_u32 s5, s5, s7
  buffer_load_dwordx4 v5, s[36:39], s5 offen lds
  s_add_u32 m0, s65, 35840
  s_add_u32 s5, s5, s7
  buffer_load_dwordx4 v5, s[36:39], s5 offen lds
  s_waitcnt lgkmcnt(0)
  v_mfma_f32_32x32x16_bf16 v[64:79], v[32:35], v[240:243], v[64:79]
  s_add_u32 m0, s65, 36864
  s_add_u32 s5, s5, s7
  buffer_load_dwordx4 v5, s[36:39], s5 offen lds
  s_add_u32 m0, s65, 37888
  s_add_u32 s5, s5, s7
  buffer_load_dwordx4 v5, s[36:39], s5 offen lds
  ds_read_b64_tr_b16 v[40:41], v12 offset:40960
  ds_read_b64_tr_b16 v[42:43], v12 offset:41984
  ds_read_b128 v[244:247], v9 offset:32768
  ds_read_b64_tr_b16 v[44:45], v13 offset:40960
  ds_read_b64_tr_b16 v[46:47], v13 offset:41984
  v_mfma_f32_32x32x16_bf16 v[80:95], v[36:39], v[240:243], v[80:95]
  s_add_u32 m0, s65, 38912
  s_add_u32 s5, s5, s7
  buffer_load_dwordx4 v5, s[36:39], s5 offen lds
  s_add_u32 m0, s65, 39936
  s_add_u32 s5, s5, s7
  buffer_load_dwordx4 v5, s[36:39], s5 offen lds
  s_waitcnt lgkmcnt(0)
  v_mfma_f32_32x32x16_bf16 v[64:79], v[40:43], v[244:247], v[64:79]
  ds_read_b64_tr_b16 v[32:33], v12 offset:49152
  ds_read_b64_tr_b16 v[34:35], v12 offset:50176
  ds_read_b128 v[248:251], v10 offset:32768
  ds_read_b64_tr_b16 v[36:37], v13 offset:49152
  ds_read_b64_tr_b16 v[38:39], v13 offset:50176
  v_mfma_f32_32x32x16_bf16 v[80:95], v[44:47], v[244:247], v[80:95]
  s_waitcnt lgkmcnt(0)
  v_mfma_f32_32x32x16_bf16 v[64:79], v[32:35], v[248:251], v[64:79]
  ds_read_b64_tr_b16 v[40:41], v12 offset:57344
  ds_read_b64_tr_b16 v[42:43], v12 offset:58368
  ds_read_b128 v[252:255], v11 offset:32768
  ds_read_b64_tr_b16 v[44:45], v13 offset:57344
  ds_read_b64_tr_b16 v[46:47], v13 offset:58368
  v_mfma_f32_32x32x16_bf16 v[80:95], v[36:39], v[248:251], v[80:95]
  s_barrier
  v_and_b32 v126, 31, v1
  v_lshlrev_b32 v127, 3, v126
  v_add_u32 v127, 159744, v127
  v_mov_b32 v24, 0
  v_mov_b32 v25, 0
  v_mov_b32 v28, 0
  v_mov_b32 v29, 0
  s_lshl_b32 s84, s60, 7
  s_add_u32 s84, s84, 161792
  v_lshl_add_u32 v126, v126, 2, s84
  ds_read_b32 v125, v126
  ds_read_b64 v[22:23], v127 offset:0
  ds_read_b64 v[26:27], v127 offset:256
  ds_read_b64 v[60:61], v127 offset:1024
  ds_read_b64 v[30:31], v127 offset:1280
  s_waitcnt lgkmcnt(5)
  v_mfma_f32_32x32x16_bf16 v[64:79], v[40:43], v[252:255], v[64:79]
  v_mfma_f32_32x32x16_bf16 v[80:95], v[44:47], v[252:255], v[80:95]
  s_waitcnt lgkmcnt(4)
  v_cmp_gt_u32 vcc, 32, v1
  v_xor_b32 v125, 0x8000, v125
  v_and_b32 v126, 0xffff, v125
  v_lshl_or_b32 v126, v126, 16, v126
  v_cndmask_b32 v16, 0, v126, vcc
  v_cndmask_b32 v17, 0, v125, vcc
  v_and_b32 v126, 0xffff0000, v125
  v_mov_b32 v18, 0
  v_mov_b32 v19, 0
  v_rcp_f32 v20, v126
  s_waitcnt lgkmcnt(0)
  v_mfma_f32_32x32x16_bf16 v[64:79], v[22:25], v[16:19], v[64:79]
  v_mfma_f32_32x32x16_bf16 v[80:95], v[26:29], v[16:19], v[80:95]
  s_waitcnt vmcnt(8)
  s_barrier
  v_mov_b32 v22, v60
  v_mov_b32 v23, v61
  v_mov_b32 v26, v30
  v_mov_b32 v27, v31
  v_xor_b32 v11, 64, v14
  s_mov_b32 s31, s59
  s_nop 2
  v_mul_f32 v64, v64, v20
  v_mul_f32 v65, v65, v20
  v_mul_f32 v66, v66, v20
  v_mul_f32 v67, v67, v20
  v_mul_f32 v68, v68, v20
  v_mul_f32 v69, v69, v20
  v_mul_f32 v70, v70, v20
  v_mul_f32 v71, v71, v20
  v_cvt_pk_bf16_f32 v48, v64, v65
  v_cvt_pk_bf16_f32 v49, v66, v67
  v_cvt_pk_bf16_f32 v50, v68, v69
  v_cvt_pk_bf16_f32 v51, v70, v71
  ds_write_b128 v96, v[48:51] offset:0
  buffer_store_dwordx4 v[48:51], v97, s[40:43], s72 offen offset:0 sc1
  v_mul_f32 v72, v72, v20
  v_mul_f32 v73, v73, v20
  v_mul_f32 v74, v74, v20
  v_mul_f32 v75, v75, v20
  v_mul_f32 v76, v76, v20
  v_mul_f32 v77, v77, v20
  v_mul_f32 v78, v78, v20
  v_mul_f32 v79, v79, v20
  v_cvt_pk_bf16_f32 v52, v72, v73
  v_cvt_pk_bf16_f32 v53, v74, v75
  v_cvt_pk_bf16_f32 v54, v76, v77
  v_cvt_pk_bf16_f32 v55, v78, v79
  ds_write_b128 v96, v[52:55] offset:16
  buffer_store_dwordx4 v[52:55], v97, s[40:43], s72 offen offset:16 sc1
  v_mul_f32 v80, v80, v20
  v_mul_f32 v81, v81, v20
  v_mul_f32 v82, v82, v20
  v_mul_f32 v83, v83, v20
  v_mul_f32 v84, v84, v20
  v_mul_f32 v85, v85, v20
  v_mul_f32 v86, v86, v20
  v_mul_f32 v87, v87, v20
  v_cvt_pk_bf16_f32 v48, v80, v81
  v_cvt_pk_bf16_f32 v49, v82, v83
  v_cvt_pk_bf16_f32 v50, v84, v85
  v_cvt_pk_bf16_f32 v51, v86, v87
  ds_write_b128 v96, v[48:51] offset:64
  buffer_store_dwordx4 v[48:51], v97, s[40:43], s72 offen offset:64 sc1
  v_mul_f32 v88, v88, v20
  v_mul_f32 v89, v89, v20
  v_mul_f32 v90, v90, v20
  v_mul_f32 v91, v91, v20
  v_mul_f32 v92, v92, v20
  v_mul_f32 v93, v93, v20
  v_mul_f32 v94, v94, v20
  v_mul_f32 v95, v95, v20
  v_cvt_pk_bf16_f32 v52, v88, v89
  v_cvt_pk_bf16_f32 v53, v90, v91
  v_cvt_pk_bf16_f32 v54, v92, v93
  v_cvt_pk_bf16_f32 v55, v94, v95
  ds_write_b128 v96, v[52:55] offset:80
  buffer_store_dwordx4 v[52:55], v97, s[40:43], s72 offen offset:80 sc1
  s_setprio 2
  ds_read_b64_tr_b16 v[32:33], v14 offset:0
  ds_read_b64_tr_b16 v[34:35], v14 offset:512
  ds_read_b64_tr_b16 v[36:37], v11 offset:0
  ds_read_b64_tr_b16 v[38:39], v11 offset:512
  ds_read_b64_tr_b16 v[40:41], v14 offset:2048
  ds_read_b64_tr_b16 v[42:43], v14 offset:2560
  ds_read_b64_tr_b16 v[44:45], v11 offset:2048
  ds_read_b64_tr_b16 v[46:47], v11 offset:2560
  ds_read_b64_tr_b16 v[112:113], v14 offset:4096
  ds_read_b64_tr_b16 v[114:115], v14 offset:4608
  ds_read_b64_tr_b16 v[116:117], v11 offset:4096
  ds_read_b64_tr_b16 v[118:119], v11 offset:4608
  v_mfma_f32_32x32x16_bf16 v[96:111], v[22:25], v[16:19], 0
  v_mfma_f32_32x32x16_bf16 v[64:79], v[26:29], v[16:19], 0
  s_waitcnt lgkmcnt(10)
  v_mfma_f32_32x32x16_bf16 v[96:111], v[32:35], v[128:131], v[96:111]
  ds_read_b64_tr_b16 v[120:121], v14 offset:6144
  ds_read_b64_tr_b16 v[122:123], v14 offset:6656
  s_waitcnt lgkmcnt(10)
  v_mfma_f32_32x32x16_bf16 v[64:79], v[36:39], v[128:131], v[64:79]
  ds_read_b64_tr_b16 v[124:125], v11 offset:6144
  ds_read_b64_tr_b16 v[126:127], v11 offset:6656
  s_waitcnt lgkmcnt(10)
  v_mfma_f32_32x32x16_bf16 v[96:111], v[40:43], v[132:135], v[96:111]
  ds_read_b64_tr_b16 v[32:33], v14 offset:8192
  ds_read_b64_tr_b16 v[34:35], v14 offset:8704
  v_mov_b32 v62, 4096
  v_mov_b32 v21, 162304
  s_mov_b64 exec, 1
  ds_add_u32 v21, v62
  s_mov_b64 exec, -1
  s_waitcnt lgkmcnt(11)
  v_mfma_f32_32x32x16_bf16 v[64:79], v[44:47], v[132:135], v[64:79]
  ds_read_b64_tr_b16 v[36:37], v11 offset:8192
  ds_read_b64_tr_b16 v[38:39], v11 offset:8704
  s_sub_u32 s87, s57, 1
  s_lshl_b32 s87, s87, 3
  s_add_u32 s87, s87, s58
  s_waitcnt lgkmcnt(11)
  v_mfma_f32_32x32x16_bf16 v[96:111], v[112:115], v[136:139], v[96:111]
  s_waitcnt vmcnt(4)
  v_mov_b32 v62, 256
  v_mov_b32 v21, 162304
  s_mov_b64 exec, 1
  ds_add_u32 v21, v62
  s_mov_b64 exec, -1
  ds_read_b64_tr_b16 v[40:41], v14 offset:10240
  ds_read_b64_tr_b16 v[42:43], v14 offset:10752
  s_lshl_b32 s91, s87, 13
  s_add_u32 s91, s91, 10747904
  s_lshl_b32 s5, s87, 7
  s_waitcnt lgkmcnt(12)
  v_mfma_f32_32x32x16_bf16 v[64:79], v[116:119], v[136:139], v[64:79]
  ds_read_b64_tr_b16 v[44:45], v11 offset:10240
  ds_read_b64_tr_b16 v[46:47], v11 offset:10752
  s_add_u32 s5, s5, 10682368
  s_cmp_eq_u32 s57, 0
  s_cselect_b32 s91, 2146435072, s91
  s_cselect_b32 s5, 10682368, s5
  s_cmp_lg_u32 s60, 0
  s_cselect_b32 s30, 1, 0
  s_waitcnt lgkmcnt(12)
  v_mfma_f32_32x32x16_bf16 v[96:111], v[120:123], v[140:143], v[96:111]
  ds_read_b64_tr_b16 v[112:113], v14 offset:12288
  ds_read_b64_tr_b16 v[114:115], v14 offset:12800
  s_mov_b32 s44, s12
  s_mov_b32 s45, s13
  s_mov_b32 s46, 524288
  s_waitcnt lgkmcnt(12)
  v_mfma_f32_32x32x16_bf16 v[64:79], v[124:127], v[140:143], v[64:79]
  ds_read_b64_tr_b16 v[116:117], v11 offset:12288
  ds_read_b64_tr_b16 v[118:119], v11 offset:12800
  s_lshl_b32 s7, s60, 17
  s_lshl_b32 s87, s68, 7
  s_add_u32 s7, s7, s87
  s_waitcnt lgkmcnt(12)
  v_mfma_f32_32x32x16_bf16 v[96:111], v[32:35], v[144:147], v[96:111]
  ds_read_b64_tr_b16 v[120:121], v14 offset:14336
  ds_read_b64_tr_b16 v[122:123], v14 offset:14848
  s_lshl_b32 s64, s60, 13
  s_lshl_b32 s101, s66, 1
  s_add_u32 s101, s101, s67
  s_waitcnt lgkmcnt(11)
  v_mfma_f32_32x32x16_bf16 v[64:79], v[36:39], v[144:147], v[64:79]
  ds_read_b64_tr_b16 v[124:125], v11 offset:14336
  ds_read_b64_tr_b16 v[126:127], v11 offset:14848
  s_lshl_b32 s86, s60, 13
  s_add_u32 s86, s86, 32768
  v_and_b32 v9, 31, v1
  s_waitcnt lgkmcnt(10)
  v_mfma_f32_32x32x16_bf16 v[96:111], v[40:43], v[148:151], v[96:111]
  ds_read_b64_tr_b16 v[32:33], v14 offset:16384
  ds_read_b64_tr_b16 v[34:35], v14 offset:16896
  v_mul_u32_u24 v9, 144, v9
  v_lshrrev_b32 v10, 5, v1
  v_lshl_add_u32 v9, v10, 5, v9
  s_waitcnt lgkmcnt(10)
  v_mfma_f32_32x32x16_bf16 v[64:79], v[44:47], v[148:151], v[64:79]
  ds_read_b64_tr_b16 v[36:37], v11 offset:16384
  ds_read_b64_tr_b16 v[38:39], v11 offset:16896
  v_add_u32 v8, s86, v9
  v_add_u32 v6, s86, v15
  v_and_b32 v12, 15, v1
  s_waitcnt lgkmcnt(10)
  v_mfma_f32_32x32x16_bf16 v[96:111], v[112:115], v[152:155], v[96:111]
  ds_read_b64_tr_b16 v[40:41], v14 offset:18432
  ds_read_b64_tr_b16 v[42:43], v14 offset:18944
  v_lshrrev_b32 v13, 4, v1
  v_and_b32 v9, 1, v13
  v_lshlrev_b32 v56, 5, v9
  s_waitcnt lgkmcnt(10)
  v_mfma_f32_32x32x16_bf16 v[64:79], v[116:119], v[152:155], v[64:79]
  ds_read_b64_tr_b16 v[44:45], v11 offset:18432
  ds_read_b64_tr_b16 v[46:47], v11 offset:18944
  v_lshl_add_u32 v56, v10, 4, v56
  s_mul_i32 s87, s60, 4608
  s_add_u32 s87, s87, 65536
  s_waitcnt lgkmcnt(10)
  v_mfma_f32_32x32x16_bf16 v[96:111], v[120:123], v[156:159], v[96:111]
  ds_read_b64_tr_b16 v[112:113], v14 offset:20480
  ds_read_b64_tr_b16 v[114:115], v14 offset:20992
  v_mul_u32_u24 v57, 288, v12
  v_add3_u32 v2, v57, v56, s87
  v_lshlrev_b32 v5, 3, v9
  s_waitcnt lgkmcnt(10)
  v_mfma_f32_32x32x16_bf16 v[64:79], v[124:127], v[156:159], v[64:79]
  ds_read_b64_tr_b16 v[116:117], v11 offset:20480
  ds_read_b64_tr_b16 v[118:119], v11 offset:20992
  v_lshl_add_u32 v5, v10, 10, v5
  v_and_b32 v9, 7, v12
  v_mul_u32_u24 v3, 288, v9
  s_waitcnt lgkmcnt(10)
  v_mfma_f32_32x32x16_bf16 v[96:111], v[32:35], v[160:163], v[96:111]
  v_mov_b32 v21, 162304
  ds_read_b32 v62, v21
  ds_read_b64_tr_b16 v[120:121], v14 offset:22528
  ds_read_b64_tr_b16 v[122:123], v14 offset:23040
  v_add3_u32 v3, v3, v56, s86
  v_lshrrev_b32 v56, 3, v12
  v_cmp_eq_u32 vcc, v56, v10
  s_waitcnt lgkmcnt(11)
  v_mfma_f32_32x32x16_bf16 v[64:79], v[36:39], v[160:163], v[64:79]
  ds_read_b64_tr_b16 v[124:125], v11 offset:22528
  ds_read_b64_tr_b16 v[126:127], v11 offset:23040
  s_add_u32 s88, s86, 4608
  v_mov_b32 v57, s88
  v_lshl_add_u32 v5, v56, 9, v5
  s_waitcnt lgkmcnt(11)
  v_mfma_f32_32x32x16_bf16 v[96:111], v[40:43], v[164:167], v[96:111]
  ds_read_b64_tr_b16 v[32:33], v14 offset:24576
  ds_read_b64_tr_b16 v[34:35], v14 offset:25088
  v_cndmask_b32 v3, v57, v3, vcc
  v_lshl_add_u32 v5, v9, 5, v5
  s_add_u32 s88, s86, 0
  s_waitcnt lgkmcnt(11)
  v_mfma_f32_32x32x16_bf16 v[64:79], v[44:47], v[164:167], v[64:79]
  ds_read_b64_tr_b16 v[36:37], v11 offset:24576
  ds_read_b64_tr_b16 v[38:39], v11 offset:25088
  v_add_u32 v5, s88, v5
  v_lshrrev_b32 v56, 2, v12
  v_lshl_add_u32 v56, v13, 2, v56
  s_waitcnt lgkmcnt(11)
  v_mfma_f32_32x32x16_bf16 v[96:111], v[112:115], v[168:171], v[96:111]
  ds_read_b64_tr_b16 v[40:41], v14 offset:26624
  ds_read_b64_tr_b16 v[42:43], v14 offset:27136
  v_mul_u32_u24 v56, 288, v56
  v_bfe_u32 v57, v12, 1, 1
  v_lshl_add_u32 v56, v57, 5, v56
  s_waitcnt lgkmcnt(11)
  v_mfma_f32_32x32x16_bf16 v[64:79], v[116:119], v[168:171], v[64:79]
  ds_read_b64_tr_b16 v[44:45], v11 offset:26624
  ds_read_b64_tr_b16 v[46:47], v11 offset:27136
  v_and_b32 v57, 1, v12
  v_lshl_add_u32 v56, v57, 3, v56
  s_add_u32 s87, s87, 20736
  s_waitcnt lgkmcnt(10)
  v_mfma_f32_32x32x16_bf16 v[96:111], v[120:123], v[172:175], v[96:111]
  ds_read_b64_tr_b16 v[112:113], v14 offset:28672
  ds_read_b64_tr_b16 v[114:115], v14 offset:29184
  v_add_u32 v4, s87, v56
  v_cmp_gt_u32 s[70:71], 8, v12
  v_lshlrev_b32 v56, 2, v13
  s_waitcnt lgkmcnt(10)
  v_mfma_f32_32x32x16_bf16 v[64:79], v[124:127], v[172:175], v[64:79]
  ds_read_b64_tr_b16 v[116:117], v11 offset:28672
  ds_read_b64_tr_b16 v[118:119], v11 offset:29184
  v_sub_u32 v56, v56, v9
  v_mov_b32 v57, 0xf149f2ca
  s_or_b32 s87, s57, s60
  s_waitcnt lgkmcnt(10)
  v_mfma_f32_32x32x16_bf16 v[96:111], v[32:35], v[176:179], v[96:111]
  v_readfirstlane_b32 s84, v62
  s_nop 0
  s_bfe_u32 s84, s84, 262152
  s_cmp_eq_u32 s84, 4
  s_cbranch_scc1 L_cok_11
L_cspin_12:
  ds_read_b32 v62, v21
  s_waitcnt lgkmcnt(0)
  v_readfirstlane_b32 s84, v62
  s_nop 0
  s_bfe_u32 s84, s84, 262152
  s_cmp_lg_u32 s84, 4
  s_cbranch_scc1 L_cspin_12
L_cok_11:
  ds_read_b64_tr_b16 v[120:121], v14 offset:30720
  ds_read_b64_tr_b16 v[122:123], v14 offset:31232
  s_cmp_eq_u32 s87, 0
  s_cselect_b32 s87, 2, 0
  v_add_u32 v9, -1, v56
  s_waitcnt lgkmcnt(10)
  v_mfma_f32_32x32x16_bf16 v[64:79], v[36:39], v[176:179], v[64:79]
  ds_read_b64_tr_b16 v[124:125], v11 offset:30720
  ds_read_b64_tr_b16 v[126:127], v11 offset:31232
  v_cmp_gt_u32 vcc, 8, v9
  v_mov_b32 v52, 0
  v_nop
  s_waitcnt lgkmcnt(10)
  v_mfma_f32_32x32x16_bf16 v[96:111], v[40:43], v[180:183], v[96:111]
  s_waitcnt vmcnt(0)
  v_mov_b32 v62, s31
  s_mov_b64 exec, 1
  buffer_store_dword v62, off, s[40:43], s83 sc1
  s_mov_b64 exec, -1
  ds_read_b64_tr_b16 v[32:33], v14 offset:32768
  ds_read_b64_tr_b16 v[34:35], v14 offset:33280
  v_cndmask_b32 v48, v57, v52, vcc
  v_add_u32 v9, 0, v56
  v_cmp_gt_u32 vcc, 8, v9
  s_waitcnt lgkmcnt(10)
  v_mfma_f32_32x32x16_bf16 v[64:79], v[44:47], v[180:183], v[64:79]
  ds_read_b64_tr_b16 v[36:37], v11 offset:32768
  ds_read_b64_tr_b16 v[38:39], v11 offset:33280
  v_mov_b32 v53, 0
  v_nop
  v_cndmask_b32 v49, v57, v53, vcc
  s_waitcnt lgkmcnt(10)
  v_mfma_f32_32x32x16_bf16 v[96:111], v[112:115], v[184:187], v[96:111]
  ds_read_b64_tr_b16 v[40:41], v14 offset:34816
  ds_read_b64_tr_b16 v[42:43], v14 offset:35328
  v_add_u32 v9, 1, v56
  v_cmp_gt_u32 vcc, 8, v9
  v_mov_b32 v54, 0
  s_waitcnt lgkmcnt(10)
  v_mfma_f32_32x32x16_bf16 v[64:79], v[116:119], v[184:187], v[64:79]
  ds_read_b64_tr_b16 v[44:45], v11 offset:34816
  ds_read_b64_tr_b16 v[46:47], v11 offset:35328
  v_nop
  v_cndmask_b32 v50, v57, v54, vcc
  v_add_u32 v9, 2, v56
  s_waitcnt lgkmcnt(10)
  v_mfma_f32_32x32x16_bf16 v[96:111], v[120:123], v[188:191], v[96:111]
  ds_read_b64_tr_b16 v[112:113], v14 offset:36864
  ds_read_b64_tr_b16 v[114:115], v14 offset:37376
  v_cmp_gt_u32 vcc, 8, v9
  v_mov_b32 v55, 0
  v_nop
  s_waitcnt lgkmcnt(10)
  v_mfma_f32_32x32x16_bf16 v[64:79], v[124:127], v[188:191], v[64:79]
  ds_read_b64_tr_b16 v[116:117], v11 offset:36864
  ds_read_b64_tr_b16 v[118:119], v11 offset:37376
  v_cndmask_b32 v51, v57, v55, vcc
  v_cmp_le_u32 vcc, s87, v13
  v_nop
  s_waitcnt lgkmcnt(10)
  v_mfma_f32_32x32x16_bf16 v[96:111], v[32:35], v[192:195], v[96:111]
  v_mov_b32 v62, 1
  v_mov_b32 v21, 162304
  s_mov_b64 exec, 1
  ds_add_u32 v21, v62
  s_mov_b64 exec, -1
  ds_read_b64_tr_b16 v[120:121], v14 offset:38912
  ds_read_b64_tr_b16 v[122:123], v14 offset:39424
  v_nop
  v_cndmask_b32 v52, v57, v48, vcc
  v_cndmask_b32 v53, v57, v49, vcc
  s_waitcnt lgkmcnt(11)
  v_mfma_f32_32x32x16_bf16 v[64:79], v[36:39], v[192:195], v[64:79]
  ds_read_b64_tr_b16 v[124:125], v11 offset:38912
  ds_read_b64_tr_b16 v[126:127], v11 offset:39424
  v_cndmask_b32 v54, v57, v50, vcc
  v_cndmask_b32 v55, v57, v51, vcc
  s_waitcnt lgkmcnt(11)
  v_mfma_f32_32x32x16_bf16 v[96:111], v[40:43], v[196:199], v[96:111]
  ds_read_b64_tr_b16 v[32:33], v14 offset:40960
  ds_read_b64_tr_b16 v[34:35], v14 offset:41472
  s_waitcnt lgkmcnt(11)
  v_mfma_f32_32x32x16_bf16 v[64:79], v[44:47], v[196:199], v[64:79]
  ds_read_b64_tr_b16 v[36:37], v11 offset:40960
  ds_read_b64_tr_b16 v[38:39], v11 offset:41472
  s_waitcnt lgkmcnt(11)
  v_mfma_f32_32x32x16_bf16 v[96:111], v[112:115], v[200:203], v[96:111]
  v_mov_b32 v21, 162304
  ds_read_b32 v62, v21
  ds_read_b64_tr_b16 v[40:41], v14 offset:43008
  ds_read_b64_tr_b16 v[42:43], v14 offset:43520
  s_waitcnt lgkmcnt(12)
  v_mfma_f32_32x32x16_bf16 v[64:79], v[116:119], v[200:203], v[64:79]
  ds_read_b64_tr_b16 v[44:45], v11 offset:43008
  ds_read_b64_tr_b16 v[46:47], v11 offset:43520
  s_waitcnt lgkmcnt(11)
  v_mfma_f32_32x32x16_bf16 v[96:111], v[120:123], v[204:207], v[96:111]
  ds_read_b64_tr_b16 v[112:113], v14 offset:45056
  ds_read_b64_tr_b16 v[114:115], v14 offset:45568
  s_waitcnt lgkmcnt(11)
  v_mfma_f32_32x32x16_bf16 v[64:79], v[124:127], v[204:207], v[64:79]
  ds_read_b64_tr_b16 v[116:117], v11 offset:45056
  ds_read_b64_tr_b16 v[118:119], v11 offset:45568
  s_waitcnt lgkmcnt(11)
  v_mfma_f32_32x32x16_bf16 v[96:111], v[32:35], v[208:211], v[96:111]
  ds_read_b64_tr_b16 v[120:121], v14 offset:47104
  ds_read_b64_tr_b16 v[122:123], v14 offset:47616
  s_waitcnt lgkmcnt(11)
  v_mfma_f32_32x32x16_bf16 v[64:79], v[36:39], v[208:211], v[64:79]
  ds_read_b64_tr_b16 v[124:125], v11 offset:47104
  ds_read_b64_tr_b16 v[126:127], v11 offset:47616
  s_waitcnt lgkmcnt(10)
  v_mfma_f32_32x32x16_bf16 v[96:111], v[40:43], v[212:215], v[96:111]
  v_readfirstlane_b32 s84, v62
  s_nop 0
  s_bfe_u32 s84, s84, 262144
  s_cmp_eq_u32 s84, 4
  s_cbranch_scc1 L_cok_13
L_cspin_14:
  ds_read_b32 v62, v21
  s_waitcnt lgkmcnt(0)
  v_readfirstlane_b32 s84, v62
  s_nop 0
  s_bfe_u32 s84, s84, 262144
  s_cmp_lg_u32 s84, 4
  s_cbranch_scc1 L_cspin_14
L_cok_13:
  ds_read_b64_tr_b16 v[32:33], v14 offset:49152
  ds_read_b64_tr_b16 v[34:35], v14 offset:49664
  s_add_u32 m0, s64, 0
  s_nop 0
  buffer_load_dwordx4 v7, s[44:47], s7 offen lds
  s_waitcnt lgkmcnt(10)
  v_mfma_f32_32x32x16_bf16 v[64:79], v[44:47], v[212:215], v[64:79]
  ds_read_b64_tr_b16 v[36:37], v11 offset:49152
  ds_read_b64_tr_b16 v[38:39], v11 offset:49664
  s_add_u32 m0, s64, 1024
  s_add_u32 s7, s7, 8192
  buffer_load_dwordx4 v7, s[44:47], s7 offen lds
  s_waitcnt lgkmcnt(10)
  v_mfma_f32_32x32x16_bf16 v[96:111], v[112:115], v[216:219], v[96:111]
  ds_read_b64_tr_b16 v[40:41], v14 offset:51200
  ds_read_b64_tr_b16 v[42:43], v14 offset:51712
  s_add_u32 m0, s64, 2048
  s_add_u32 s7, s7, 8192
  buffer_load_dwordx4 v7, s[44:47], s7 offen lds
  s_waitcnt lgkmcnt(10)
  v_mfma_f32_32x32x16_bf16 v[64:79], v[116:119], v[216:219], v[64:79]
  ds_read_b64_tr_b16 v[44:45], v11 offset:51200
  ds_read_b64_tr_b16 v[46:47], v11 offset:51712
  s_add_u32 m0, s64, 3072
  s_add_u32 s7, s7, 8192
  buffer_load_dwordx4 v7, s[44:47], s7 offen lds
  s_waitcnt lgkmcnt(10)
  v_mfma_f32_32x32x16_bf16 v[96:111], v[120:123], v[220:223], v[96:111]
  s_load_dwordx2 s[14:15], s[28:29], s5 glc
  ds_read_b64_tr_b16 v[112:113], v14 offset:53248
  ds_read_b64_tr_b16 v[114:115], v14 offset:53760
  s_add_u32 m0, s64, 4096
  s_add_u32 s7, s7, 8192
  buffer_load_dwordx4 v7, s[44:47], s7 offen lds
  s_waitcnt lgkmcnt(10)
  v_mfma_f32_32x32x16_bf16 v[64:79], v[124:127], v[220:223], v[64:79]
  ds_read_b64_tr_b16 v[116:117], v11 offset:53248
  ds_read_b64_tr_b16 v[118:119], v11 offset:53760
  s_add_u32 m0, s64, 5120
  s_add_u32 s7, s7, 8192
  buffer_load_dwordx4 v7, s[44:47], s7 offen lds
  s_waitcnt lgkmcnt(10)
  v_mfma_f32_32x32x16_bf16 v[96:111], v[32:35], v[224:227], v[96:111]
  ds_read_b64_tr_b16 v[120:121], v14 offset:55296
  ds_read_b64_tr_b16 v[122:123], v14 offset:55808
  s_add_u32 m0, s64, 6144
  s_add_u32 s7, s7, 8192
  buffer_load_dwordx4 v7, s[44:47], s7 offen lds
  s_waitcnt lgkmcnt(10)
  v_mfma_f32_32x32x16_bf16 v[64:79], v[36:39], v[224:227], v[64:79]
  ds_read_b64_tr_b16 v[124:125], v11 offset:55296
  ds_read_b64_tr_b16 v[126:127], v11 offset:55808
  s_add_u32 m0, s64, 7168
  s_add_u32 s7, s7, 8192
  buffer_load_dwordx4 v7, s[44:47], s7 offen lds
  s_waitcnt lgkmcnt(10)
  v_mfma_f32_32x32x16_bf16 v[96:111], v[40:43], v[228:231], v[96:111]
  ds_read_b64_tr_b16 v[32:33], v14 offset:57344
  ds_read_b64_tr_b16 v[34:35], v14 offset:57856
  s_waitcnt lgkmcnt(10)
  v_mfma_f32_32x32x16_bf16 v[64:79], v[44:47], v[228:231], v[64:79]
  ds_read_b64_tr_b16 v[36:37], v11 offset:57344
  ds_read_b64_tr_b16 v[38:39], v11 offset:57856
  s_waitcnt lgkmcnt(10)
  v_mfma_f32_32x32x16_bf16 v[96:111], v[112:115], v[232:235], v[96:111]
  ds_read_b64_tr_b16 v[40:41], v14 offset:59392
  ds_read_b64_tr_b16 v[42:43], v14 offset:59904
  s_waitcnt lgkmcnt(10)
  v_mfma_f32_32x32x16_bf16 v[64:79], v[116:119], v[232:235], v[64:79]
  ds_read_b64_tr_b16 v[44:45], v11 offset:59392
  ds_read_b64_tr_b16 v[46:47], v11 offset:59904
  s_waitcnt lgkmcnt(10)
  v_mfma_f32_32x32x16_bf16 v[96:111], v[120:123], v[236:239], v[96:111]
  ds_read_b64_tr_b16 v[112:113], v14 offset:61440
  ds_read_b64_tr_b16 v[114:115], v14 offset:61952
  s_waitcnt lgkmcnt(10)
  v_mfma_f32_32x32x16_bf16 v[64:79], v[124:127], v[236:239], v[64:79]
  ds_read_b64_tr_b16 v[116:117], v11 offset:61440
  ds_read_b64_tr_b16 v[118:119], v11 offset:61952
  s_waitcnt lgkmcnt(10)
  v_mfma_f32_32x32x16_bf16 v[96:111], v[32:35], v[240:243], v[96:111]
  ds_read_b64_tr_b16 v[120:121], v14 offset:63488
  ds_read_b64_tr_b16 v[122:123], v14 offset:64000
  s_waitcnt lgkmcnt(10)
  v_mfma_f32_32x32x16_bf16 v[64:79], v[36:39], v[240:243], v[64:79]
  ds_read_b64_tr_b16 v[124:125], v11 offset:63488
  ds_read_b64_tr_b16 v[126:127], v11 offset:64000
  s_waitcnt lgkmcnt(10)
  v_mfma_f32_32x32x16_bf16 v[96:111], v[40:43], v[244:247], v[96:111]
  s_cmp_lg_u32 s30, 0
  s_cbranch_scc1 L_hskip_15
  s_waitcnt lgkmcnt(0)
  s_cmp_eq_u32 s57, 0
  s_cbranch_scc1 L_hgo_16
  s_xor_b32 s14, s14, s59
  s_xor_b32 s15, s15, s59
  s_or_b32 s14, s14, s15
  s_cbranch_scc1 L_hskip_15
L_hgo_16:
  s_mov_b32 s30, 1
  s_add_u32 s84, s91, 0
  s_mov_b32 m0, 65536
  s_nop 0
  buffer_load_dwordx4 v15, s[40:43], s84 offen offset:0 sc1 lds
  buffer_load_dwordx4 v15, s[40:43], s84 offen offset:1024 sc1 lds
  s_mov_b64 exec, 0xffff
  buffer_load_dwordx4 v15, s[40:43], s84 offen offset:2048 sc1 lds
  s_mov_b64 exec, -1
  s_add_u32 s84, s91, 4096
  s_mov_b32 m0, 86272
  s_nop 0
  buffer_load_dwordx4 v15, s[40:43], s84 offen offset:0 sc1 lds
  buffer_load_dwordx4 v15, s[40:43], s84 offen offset:1024 sc1 lds
  s_mov_b64 exec, 0xffff
  buffer_load_dwordx4 v15, s[40:43], s84 offen offset:2048 sc1 lds
  s_mov_b64 exec, -1
L_hskip_15:
  s_waitcnt lgkmcnt(8)
  v_mfma_f32_32x32x16_bf16 v[64:79], v[44:47], v[244:247], v[64:79]
  s_waitcnt lgkmcnt(6)
  v_mfma_f32_32x32x16_bf16 v[96:111], v[112:115], v[248:251], v[96:111]
  s_waitcnt lgkmcnt(4)
  v_mfma_f32_32x32x16_bf16 v[64:79], v[116:119], v[248:251], v[64:79]
  s_waitcnt lgkmcnt(2)
  v_mfma_f32_32x32x16_bf16 v[96:111], v[120:123], v[252:255], v[96:111]
  s_waitcnt lgkmcnt(0)
  v_mfma_f32_32x32x16_bf16 v[64:79], v[124:127], v[252:255], v[64:79]
  s_setprio 0
  v_mov_b32 v62, 1048576
  v_mov_b32 v21, 162304
  s_mov_b64 exec, 1
  ds_add_u32 v21, v62
  s_mov_b64 exec, -1
  s_nop 3
  v_mul_f32 v96, v96, v20
  v_mul_f32 v97, v97, v20
  v_mul_f32 v98, v98, v20
  v_mul_f32 v99, v99, v20
  v_mul_f32 v100, v100, v20
  v_mul_f32 v101, v101, v20
  v_mul_f32 v102, v102, v20
  v_mul_f32 v103, v103, v20
  v_mul_f32 v104, v104, v20
  v_mul_f32 v105, v105, v20
  v_mul_f32 v106, v106, v20
  v_mul_f32 v107, v107, v20
  v_mul_f32 v108, v108, v20
  v_mul_f32 v109, v109, v20
  v_mul_f32 v110, v110, v20
  v_mul_f32 v111, v111, v20
  v_cvt_pk_bf16_f32 v80, v96, v97
  v_cvt_pk_bf16_f32 v81, v98, v99
  v_cvt_pk_bf16_f32 v82, v100, v101
  v_cvt_pk_bf16_f32 v83, v102, v103
  v_cvt_pk_bf16_f32 v84, v104, v105
  v_cvt_pk_bf16_f32 v85, v106, v107
  v_cvt_pk_bf16_f32 v86, v108, v109
  v_cvt_pk_bf16_f32 v87, v110, v111
  v_mul_f32 v64, v64, v20
  v_mul_f32 v65, v65, v20
  v_mul_f32 v66, v66, v20
  v_mul_f32 v67, v67, v20
  v_mul_f32 v68, v68, v20
  v_mul_f32 v69, v69, v20
  v_mul_f32 v70, v70, v20
  v_mul_f32 v71, v71, v20
  v_mul_f32 v72, v72, v20
  v_mul_f32 v73, v73, v20
  v_mul_f32 v74, v74, v20
  v_mul_f32 v75, v75, v20
  v_mul_f32 v76, v76, v20
  v_mul_f32 v77, v77, v20
  v_mul_f32 v78, v78, v20
  v_mul_f32 v79, v79, v20
  v_cvt_pk_bf16_f32 v88, v64, v65
  v_cvt_pk_bf16_f32 v89, v66, v67
  v_cvt_pk_bf16_f32 v90, v68, v69
  v_cvt_pk_bf16_f32 v91, v70, v71
  v_cvt_pk_bf16_f32 v92, v72, v73
  v_cvt_pk_bf16_f32 v93, v74, v75
  v_cvt_pk_bf16_f32 v94, v76, v77
  v_cvt_pk_bf16_f32 v95, v78, v79
  v_mov_b32 v21, 162304
  ds_read_b32 v62, v21
  s_cmp_lg_u32 s30, 0
  s_cbranch_scc1 L_hskip_18
  s_mov_b32 s89, 0
L_hspin_20:
  s_load_dwordx2 s[14:15], s[28:29], s5 glc
  s_waitcnt lgkmcnt(0)
  s_cmp_eq_u32 s57, 0
  s_cbranch_scc1 L_hgo_19
  s_xor_b32 s14, s14, s59
  s_xor_b32 s15, s15, s59
  s_or_b32 s14, s14, s15
  s_cbranch_scc0 L_hgo_19
  s_sleep 2
  s_add_u32 s89, s89, 1
  s_cmp_lt_u32 s89, 0x20000
  s_cbranch_scc1 L_hspin_20
L_hgo_19:
  s_mov_b32 s30, 1
  s_add_u32 s84, s91, 0
  s_mov_b32 m0, 65536
  s_nop 0
  buffer_load_dwordx4 v15, s[40:43], s84 offen offset:0 sc1 lds
  buffer_load_dwordx4 v15, s[40:43], s84 offen offset:1024 sc1 lds
  s_mov_b64 exec, 0xffff
  buffer_load_dwordx4 v15, s[40:43], s84 offen offset:2048 sc1 lds
  s_mov_b64 exec, -1
  s_add_u32 s84, s91, 4096
  s_mov_b32 m0, 86272
  s_nop 0
  buffer_load_dwordx4 v15, s[40:43], s84 offen offset:0 sc1 lds
  buffer_load_dwordx4 v15, s[40:43], s84 offen offset:1024 sc1 lds
  s_mov_b64 exec, 0xffff
  buffer_load_dwordx4 v15, s[40:43], s84 offen offset:2048 sc1 lds
  s_mov_b64 exec, -1
L_hskip_18:
  v_mov_b32 v24, 0
  v_mov_b32 v25, 0
  v_mov_b32 v26, 0
  v_mov_b32 v27, 0
  s_waitcnt lgkmcnt(0)
  v_readfirstlane_b32 s84, v62
  s_nop 0
  s_bfe_u32 s84, s84, 262164
  s_cmp_eq_u32 s84, 4
  s_cbranch_scc1 L_cok_21
L_cspin_22:
  ds_read_b32 v62, v21
  s_waitcnt lgkmcnt(0)
  v_readfirstlane_b32 s84, v62
  s_nop 0
  s_bfe_u32 s84, s84, 262164
  s_cmp_lg_u32 s84, 4
  s_cbranch_scc1 L_cspin_22
L_cok_21:
  v_readfirstlane_b32 s84, v62
  ds_write_b128 v8, v[80:83] offset:0
  ds_write_b128 v8, v[84:87] offset:16
  ds_write_b128 v8, v[88:91] offset:64
  ds_write_b128 v8, v[92:95] offset:80
  ds_write_b128 v6, v[24:27] offset:4608
  ds_write_b128 v6, v[24:27] offset:5632
  ds_write_b128 v6, v[24:27] offset:6400
  v_mov_b32 v16, 0x3f803f80
  v_mov_b32 v17, 0x3f803f80
  v_mov_b32 v18, 0x3f803f80
  v_mov_b32 v19, 0x3f803f80
  s_bfe_u32 s84, s84, 0x4000c
  s_cmp_eq_u32 s84, 8
  s_cbranch_scc1 L_kvok_23
  v_mov_b32 v21, 162304
  ds_read_b32 v62, v21
  s_waitcnt lgkmcnt(0)
  v_readfirstlane_b32 s84, v62
  s_nop 0
  s_bfe_u32 s84, s84, 262156
  s_cmp_eq_u32 s84, 8
  s_cbranch_scc1 L_cok_24
L_cspin_25:
  ds_read_b32 v62, v21
  s_waitcnt lgkmcnt(0)
  v_readfirstlane_b32 s84, v62
  s_nop 0
  s_bfe_u32 s84, s84, 262156
  s_cmp_lg_u32 s84, 8
  s_cbranch_scc1 L_cspin_25
L_cok_24:
L_kvok_23:
  s_waitcnt vmcnt(0)
  ds_read_b128 v[128:131], v2 offset:0
  ds_read_b128 v[136:139], v2 offset:144
  ds_read_b128 v[144:147], v2 offset:2304
  ds_read_b128 v[152:155], v2 offset:2448
  ds_read_b128 v[160:163], v2 offset:64
  ds_read_b128 v[168:171], v2 offset:208
  ds_read_b128 v[176:179], v2 offset:2368
  ds_read_b128 v[184:187], v2 offset:2512
  s_waitcnt lgkmcnt(8)
  ds_read_b128 v[132:135], v3 offset:0
  ds_read_b128 v[140:143], v3 offset:144
  ds_read_b128 v[148:151], v3 offset:2304
  ds_read_b128 v[156:159], v3 offset:2448
  ds_read_b128 v[164:167], v3 offset:64
  ds_read_b128 v[172:175], v3 offset:208
  ds_read_b128 v[180:183], v3 offset:2368
  ds_read_b128 v[188:191], v3 offset:2512
  s_waitcnt lgkmcnt(7)
  v_mfma_f32_16x16x32_bf16 v[64:67], v[128:131], v[132:135], v[52:55]
  ds_read_b64_tr_b16 v[192:193], v4 offset:0
  ds_read_b64_tr_b16 v[194:195], v4 offset:16
  s_waitcnt lgkmcnt(8)
  v_mfma_f32_16x16x32_bf16 v[68:71], v[136:139], v[140:143], v[52:55]
  ds_read_b64_tr_b16 v[196:197], v4 offset:144
  ds_read_b64_tr_b16 v[198:199], v4 offset:160
  s_waitcnt lgkmcnt(9)
  v_mfma_f32_16x16x32_bf16 v[72:75], v[144:147], v[148:151], v[48:51]
  ds_read_b64_tr_b16 v[200:201], v4 offset:2304
  ds_read_b64_tr_b16 v[202:203], v4 offset:2320
  s_waitcnt lgkmcnt(10)
  v_mfma_f32_16x16x32_bf16 v[76:79], v[152:155], v[156:159], v[48:51]
  ds_read_b64_tr_b16 v[204:205], v4 offset:2448
  ds_read_b64_tr_b16 v[206:207], v4 offset:2464
  s_waitcnt lgkmcnt(11)
  v_mfma_f32_16x16x32_bf16 v[80:83], v[160:163], v[164:167], v[52:55]
  ds_read_b64_tr_b16 v[208:209], v4 offset:64
  ds_read_b64_tr_b16 v[210:211], v4 offset:80
  s_waitcnt lgkmcnt(12)
  v_mfma_f32_16x16x32_bf16 v[84:87], v[168:171], v[172:175], v[52:55]
  ds_read_b64_tr_b16 v[212:213], v4 offset:208
  ds_read_b64_tr_b16 v[214:215], v4 offset:224
  s_waitcnt lgkmcnt(13)
  v_mfma_f32_16x16x32_bf16 v[88:91], v[176:179], v[180:183], v[48:51]
  ds_read_b64_tr_b16 v[216:217], v4 offset:2368
  ds_read_b64_tr_b16 v[218:219], v4 offset:2384
  s_waitcnt lgkmcnt(14)
  v_mfma_f32_16x16x32_bf16 v[92:95], v[184:187], v[188:191], v[48:51]
  ds_read_b64_tr_b16 v[220:221], v4 offset:2512
  ds_read_b64_tr_b16 v[222:223], v4 offset:2528
  s_mov_b32 s84, 0x3eb8aa3b
  v_max3_f32 v224, v64, v65, v66
  v_max3_f32 v225, v68, v69, v70
  v_max3_f32 v226, v72, v73, v74
  v_max3_f32 v227, v76, v77, v78
  v_max3_f32 v228, v80, v81, v82
  v_max3_f32 v229, v84, v85, v86
  v_max3_f32 v230, v88, v89, v90
  v_max3_f32 v231, v92, v93, v94
  v_max_f32 v224, v224, v67
  v_max_f32 v225, v225, v71
  v_max_f32 v226, v226, v75
  v_max_f32 v227, v227, v79
  v_max_f32 v228, v228, v83
  v_max_f32 v229, v229, v87
  v_max_f32 v230, v230, v91
  v_max_f32 v231, v231, v95
  v_permlane16_swap_b32 v224, v225
  v_permlane16_swap_b32 v226, v227
  v_permlane16_swap_b32 v228, v229
  v_permlane16_swap_b32 v230, v231
  v_max_f32 v224, v224, v225
  v_max_f32 v226, v226, v227
  v_max_f32 v228, v228, v229
  v_max_f32 v230, v230, v231
  v_permlane32_swap_b32 v224, v226
  s_nop 0
  v_permlane32_swap_b32 v228, v230
  v_max_f32 v224, v224, v226
  v_max_f32 v228, v228, v230
  v_mul_f32 v224, s84, v224
  v_mul_f32 v228, s84, v228
  v_mov_b32 v226, v224
  v_mov_b32 v230, v228
  s_nop 0
  v_permlane32_swap_b32 v224, v226
  v_permlane32_swap_b32 v228, v230
  v_mov_b32 v225, v224
  v_mov_b32 v227, v226
  v_mov_b32 v229, v228
  v_mov_b32 v231, v230
  v_permlane16_swap_b32 v224, v225
  v_permlane16_swap_b32 v226, v227
  v_permlane16_swap_b32 v228, v229
  v_permlane16_swap_b32 v230, v231
  s_lshl_b32 s85, s58, 12
  s_add_u32 s85, s85, s77
  v_fma_f32 v64, v64, s84, -v224
  v_fma_f32 v65, v65, s84, -v224
  v_fma_f32 v66, v66, s84, -v224
  v_fma_f32 v67, v67, s84, -v224
  v_exp_f32 v64, v64
  v_exp_f32 v65, v65
  v_exp_f32 v66, v66
  v_exp_f32 v67, v67
  v_fma_f32 v68, v68, s84, -v225
  v_fma_f32 v69, v69, s84, -v225
  v_fma_f32 v70, v70, s84, -v225
  v_fma_f32 v71, v71, s84, -v225
  v_exp_f32 v68, v68
  v_exp_f32 v69, v69
  v_exp_f32 v70, v70
  v_exp_f32 v71, v71
  v_cvt_pk_bf16_f32 v232, v64, v65
  v_cvt_pk_bf16_f32 v233, v66, v67
  v_cndmask_b32 v96, 0, v232, s[70:71]
  v_cndmask_b32 v97, 0, v233, s[70:71]
  v_cndmask_b32 v98, v232, 0, s[70:71]
  v_cndmask_b32 v99, v233, 0, s[70:71]
  v_fma_f32 v72, v72, s84, -v226
  v_fma_f32 v73, v73, s84, -v226
  v_fma_f32 v74, v74, s84, -v226
  v_fma_f32 v75, v75, s84, -v226
  v_exp_f32 v72, v72
  v_exp_f32 v73, v73
  v_exp_f32 v74, v74
  v_exp_f32 v75, v75
  v_cvt_pk_bf16_f32 v234, v68, v69
  v_cvt_pk_bf16_f32 v235, v70, v71
  v_cndmask_b32 v100, 0, v234, s[70:71]
  v_cndmask_b32 v101, 0, v235, s[70:71]
  v_cndmask_b32 v102, v234, 0, s[70:71]
  v_cndmask_b32 v103, v235, 0, s[70:71]
  s_waitcnt lgkmcnt(14)
  v_mfma_f32_16x16x32_bf16 v[128:131], v[16:19], v[96:99], 0
  v_mfma_f32_16x16x32_bf16 v[160:163], v[192:195], v[96:99], 0
  v_fma_f32 v76, v76, s84, -v227
  v_fma_f32 v77, v77, s84, -v227
  v_fma_f32 v78, v78, s84, -v227
  v_fma_f32 v79, v79, s84, -v227
  v_exp_f32 v76, v76
  v_exp_f32 v77, v77
  v_exp_f32 v78, v78
  v_exp_f32 v79, v79
  v_cvt_pk_bf16_f32 v232, v72, v73
  v_cvt_pk_bf16_f32 v233, v74, v75
  v_cndmask_b32 v104, 0, v232, s[70:71]
  v_cndmask_b32 v105, 0, v233, s[70:71]
  v_cndmask_b32 v106, v232, 0, s[70:71]
  v_cndmask_b32 v107, v233, 0, s[70:71]
  s_waitcnt lgkmcnt(12)
  v_mfma_f32_16x16x32_bf16 v[132:135], v[16:19], v[100:103], 0
  v_mfma_f32_16x16x32_bf16 v[164:167], v[196:199], v[100:103], 0
  v_fma_f32 v80, v80, s84, -v228
  v_fma_f32 v81, v81, s84, -v228
  v_fma_f32 v82, v82, s84, -v228
  v_fma_f32 v83, v83, s84, -v228
  v_exp_f32 v80, v80
  v_exp_f32 v81, v81
  v_exp_f32 v82, v82
  v_exp_f32 v83, v83
  v_cvt_pk_bf16_f32 v234, v76, v77
  v_cvt_pk_bf16_f32 v235, v78, v79
  v_cndmask_b32 v108, 0, v234, s[70:71]
  v_cndmask_b32 v109, 0, v235, s[70:71]
  v_cndmask_b32 v110, v234, 0, s[70:71]
  v_cndmask_b32 v111, v235, 0, s[70:71]
  s_waitcnt lgkmcnt(10)
  v_mfma_f32_16x16x32_bf16 v[136:139], v[16:19], v[104:107], 0
  v_mfma_f32_16x16x32_bf16 v[168:171], v[200:203], v[104:107], 0
  v_rcp_f32 v128, v128
  v_fma_f32 v84, v84, s84, -v229
  v_fma_f32 v85, v85, s84, -v229
  v_fma_f32 v86, v86, s84, -v229
  v_fma_f32 v87, v87, s84, -v229
  v_exp_f32 v84, v84
  v_exp_f32 v85, v85
  v_exp_f32 v86, v86
  v_exp_f32 v87, v87
  v_cvt_pk_bf16_f32 v232, v80, v81
  v_cvt_pk_bf16_f32 v233, v82, v83
  v_cndmask_b32 v112, 0, v232, s[70:71]
  v_cndmask_b32 v113, 0, v233, s[70:71]
  v_cndmask_b32 v114, v232, 0, s[70:71]
  v_cndmask_b32 v115, v233, 0, s[70:71]
  s_waitcnt lgkmcnt(8)
  v_mfma_f32_16x16x32_bf16 v[140:143], v[16:19], v[108:111], 0
  v_mfma_f32_16x16x32_bf16 v[172:175], v[204:207], v[108:111], 0
  v_rcp_f32 v132, v132
  v_mul_f32 v160, v160, v128
  v_mul_f32 v161, v161, v128
  v_mul_f32 v162, v162, v128
  v_mul_f32 v163, v163, v128
  v_cvt_pk_bf16_f32 v160, v160, v161
  v_cvt_pk_bf16_f32 v161, v162, v163
  ds_write_b64 v5, v[160:161] offset:0
  v_fma_f32 v88, v88, s84, -v230
  v_fma_f32 v89, v89, s84, -v230
  v_fma_f32 v90, v90, s84, -v230
  v_fma_f32 v91, v91, s84, -v230
  v_exp_f32 v88, v88
  v_exp_f32 v89, v89
  v_exp_f32 v90, v90
  v_exp_f32 v91, v91
  v_cvt_pk_bf16_f32 v234, v84, v85
  v_cvt_pk_bf16_f32 v235, v86, v87
  v_cndmask_b32 v116, 0, v234, s[70:71]
  v_cndmask_b32 v117, 0, v235, s[70:71]
  v_cndmask_b32 v118, v234, 0, s[70:71]
  v_cndmask_b32 v119, v235, 0, s[70:71]
  s_waitcnt lgkmcnt(7)
  v_mfma_f32_16x16x32_bf16 v[144:147], v[16:19], v[112:115], 0
  v_mfma_f32_16x16x32_bf16 v[176:179], v[208:211], v[112:115], 0
  v_rcp_f32 v136, v136
  v_mul_f32 v164, v164, v132
  v_mul_f32 v165, v165, v132
  v_mul_f32 v166, v166, v132
  v_mul_f32 v167, v167, v132
  v_cvt_pk_bf16_f32 v164, v164, v165
  v_cvt_pk_bf16_f32 v165, v166, v167
  ds_write_b64 v5, v[164:165] offset:16
  v_fma_f32 v92, v92, s84, -v231
  v_fma_f32 v93, v93, s84, -v231
  v_fma_f32 v94, v94, s84, -v231
  v_fma_f32 v95, v95, s84, -v231
  v_exp_f32 v92, v92
  v_exp_f32 v93, v93
  v_exp_f32 v94, v94
  v_exp_f32 v95, v95
  v_cvt_pk_bf16_f32 v232, v88, v89
  v_cvt_pk_bf16_f32 v233, v90, v91
  v_cndmask_b32 v120, 0, v232, s[70:71]
  v_cndmask_b32 v121, 0, v233, s[70:71]
  v_cndmask_b32 v122, v232, 0, s[70:71]
  v_cndmask_b32 v123, v233, 0, s[70:71]
  s_waitcnt lgkmcnt(6)
  v_mfma_f32_16x16x32_bf16 v[148:151], v[16:19], v[116:119], 0
  v_mfma_f32_16x16x32_bf16 v[180:183], v[212:215], v[116:119], 0
  v_rcp_f32 v140, v140
  v_mul_f32 v168, v168, v136
  v_mul_f32 v169, v169, v136
  v_mul_f32 v170, v170, v136
  v_mul_f32 v171, v171, v136
  v_cvt_pk_bf16_f32 v168, v168, v169
  v_cvt_pk_bf16_f32 v169, v170, v171
  ds_write_b64 v5, v[168:169] offset:256
  v_cvt_pk_bf16_f32 v234, v92, v93
  v_cvt_pk_bf16_f32 v235, v94, v95
  v_cndmask_b32 v124, 0, v234, s[70:71]
  v_cndmask_b32 v125, 0, v235, s[70:71]
  v_cndmask_b32 v126, v234, 0, s[70:71]
  v_cndmask_b32 v127, v235, 0, s[70:71]
  s_waitcnt lgkmcnt(5)
  v_mfma_f32_16x16x32_bf16 v[152:155], v[16:19], v[120:123], 0
  v_mfma_f32_16x16x32_bf16 v[184:187], v[216:219], v[120:123], 0
  v_rcp_f32 v144, v144
  v_mul_f32 v172, v172, v140
  v_mul_f32 v173, v173, v140
  v_mul_f32 v174, v174, v140
  v_mul_f32 v175, v175, v140
  v_cvt_pk_bf16_f32 v172, v172, v173
  v_cvt_pk_bf16_f32 v173, v174, v175
  ds_write_b64 v5, v[172:173] offset:272
  s_waitcnt lgkmcnt(4)
  v_mfma_f32_16x16x32_bf16 v[156:159], v[16:19], v[124:127], 0
  v_mfma_f32_16x16x32_bf16 v[188:191], v[220:223], v[124:127], 0
  v_rcp_f32 v148, v148
  v_mul_f32 v176, v176, v144
  v_mul_f32 v177, v177, v144
  v_mul_f32 v178, v178, v144
  v_mul_f32 v179, v179, v144
  v_cvt_pk_bf16_f32 v176, v176, v177
  v_cvt_pk_bf16_f32 v177, v178, v179
  ds_write_b64 v5, v[176:177] offset:2048
  s_waitcnt lgkmcnt(1)
  ds_read_b128 v[64:67], v6 offset:0
  ds_read_b128 v[68:71], v6 offset:1024
  v_rcp_f32 v152, v152
  v_mul_f32 v180, v180, v148
  v_mul_f32 v181, v181, v148
  v_mul_f32 v182, v182, v148
  v_mul_f32 v183, v183, v148
  v_cvt_pk_bf16_f32 v180, v180, v181
  v_cvt_pk_bf16_f32 v181, v182, v183
  ds_write_b64 v5, v[180:181] offset:2064
  v_rcp_f32 v156, v156
  v_mul_f32 v184, v184, v152
  v_mul_f32 v185, v185, v152
  v_mul_f32 v186, v186, v152
  v_mul_f32 v187, v187, v152
  v_cvt_pk_bf16_f32 v184, v184, v185
  v_cvt_pk_bf16_f32 v185, v186, v187
  ds_write_b64 v5, v[184:185] offset:2304
  v_mul_f32 v188, v188, v156
  v_mul_f32 v189, v189, v156
  v_mul_f32 v190, v190, v156
  v_mul_f32 v191, v191, v156
  v_cvt_pk_bf16_f32 v188, v188, v189
  v_cvt_pk_bf16_f32 v189, v190, v191
  ds_write_b64 v5, v[188:189] offset:2320
  s_waitcnt lgkmcnt(4)
  buffer_store_dwordx4 v[64:67], v15, s[40:43], s85 offen offset:0 sc1
  s_waitcnt lgkmcnt(3)
  buffer_store_dwordx4 v[68:71], v15, s[40:43], s85 offen offset:1024 sc1
  s_waitcnt lgkmcnt(0)
  ds_read_b128 v[72:75], v6 offset:2048
  ds_read_b128 v[76:79], v6 offset:3072
  s_waitcnt lgkmcnt(1)
  buffer_store_dwordx4 v[72:75], v15, s[40:43], s85 offen offset:2048 sc1
  s_waitcnt lgkmcnt(0)
  buffer_store_dwordx4 v[76:79], v15, s[40:43], s85 offen offset:3072 sc1
  v_mov_b32 v62, 16
  v_mov_b32 v21, 162304
  s_mov_b64 exec, 1
  ds_add_u32 v21, v62
  s_mov_b64 exec, -1
  s_add_u32 m0, s64, 32768
  s_add_u32 s7, s7, 8192
  buffer_load_dwordx4 v7, s[44:47], s7 offen lds
  s_add_u32 m0, s64, 33792
  s_add_u32 s7, s7, 8192
  buffer_load_dwordx4 v7, s[44:47], s7 offen lds
  s_add_u32 m0, s64, 34816
  s_add_u32 s7, s7, 8192
  buffer_load_dwordx4 v7, s[44:47], s7 offen lds
  s_add_u32 m0, s64, 35840
  s_add_u32 s7, s7, 8192
  buffer_load_dwordx4 v7, s[44:47], s7 offen lds
  s_add_u32 m0, s64, 36864
  s_add_u32 s7, s7, 8192
  buffer_load_dwordx4 v7, s[44:47], s7 offen lds
  s_add_u32 m0, s64, 37888
  s_add_u32 s7, s7, 8192
  buffer_load_dwordx4 v7, s[44:47], s7 offen lds
  s_add_u32 m0, s64, 38912
  s_add_u32 s7, s7, 8192
  buffer_load_dwordx4 v7, s[44:47], s7 offen lds
  s_add_u32 m0, s64, 39936
  s_add_u32 s7, s7, 8192
  buffer_load_dwordx4 v7, s[44:47], s7 offen lds
  v_bfe_u32 v22, v1, 2, 2
  v_lshrrev_b32 v23, 5, v1
  v_lshl_add_u32 v23, v23, 4, v22
  v_lshlrev_b32 v23, 7, v23
  v_lshrrev_b32 v22, 1, v22
  v_lshl_add_u32 v23, v22, 6, v23
  v_bfe_u32 v22, v1, 4, 1
  v_lshl_add_u32 v23, v22, 5, v23
  v_and_b32 v22, 3, v1
  v_lshl_add_u32 v23, v22, 3, v23
  v_add_u32 v4, s64, v23
  v_xor_b32 v5, 64, v4
  v_add_u32 v3, 147456, v15
  s_lshl_b32 s84, s66, 1
  s_add_u32 s84, s84, s67
  s_mul_i32 s63, s84, 294912
  s_mul_i32 s84, s60, 8192
  s_add_u32 s63, s63, s84
  s_lshl_b32 s90, s66, 1
  s_add_u32 s90, s90, s67
  s_lshl_b32 s90, s90, 10
  s_lshl_b32 s85, s60, 7
  s_add_u32 s90, s90, s85
  s_add_u32 s90, s90, 10698752
  s_waitcnt vmcnt(8)
  s_add_u32 s84, s59, 3
  v_mov_b32 v62, s84
  s_mov_b64 exec, 1
  buffer_store_dword v62, off, s[40:43], s80 sc1
  s_mov_b64 exec, -1
  s_branch L_p3s
L_qkv_h1:
  s_mov_b32 s36, s10
  s_mov_b32 s37, s11
  s_mov_b32 s38, 1572864
  s_mov_b32 s39, 0x20000
  s_movk_i32 s62, 3072
  s_movk_i32 s3, 12288
  v_xor_b32 v11, v8, v9
  v_lshlrev_b32 v11, 4, v11
  v_lshl_add_u32 v2, v10, 10, v11
  v_xor_b32 v3, 64, v2
  v_add_u32 v3, 8192, v3
  s_lshl_b32 s65, s56, 12
  s_lshl_b32 s63, s57, 3
  s_add_u32 s63, s63, s56
  s_lshl_b32 s63, s63, 14
  v_and_b32 v12, 15, v1
  v_lshlrev_b32 v13, 2, v9
  v_xor_b32 v12, v12, v13
  s_lshl_b32 s69, s58, 7
  s_add_u32 s69, s69, 1024
  v_lshrrev_b32 v13, 3, v12
  v_lshlrev_b32 v13, 10, v13
  v_and_b32 v12, 7, v12
  v_lshl_add_u32 v12, v12, 4, v13
  v_mad_u32_u24 v4, v9, s62, v12
  s_mul_i32 s64, s56, 24576
  s_add_u32 s64, s64, s69
  s_mov_b32 s87, 10731520
  s_load_dword s73, s[28:29], s87
  s_mov_b32 s74, 0x3f803f80
  s_mov_b32 s75, 0x00003f80
  s_mov_b32 s76, 0x3f800000
  s_mov_b32 s40, s28
  s_mov_b32 s41, s29
  s_mov_b32 s42, 14155776
  s_mov_b32 s43, 0x20000
  v_and_b32 v14, 3, v1
  v_and_b32 v22, 1, v9
  v_lshlrev_b32 v26, 12, v22
  v_lshlrev_b32 v25, 2, v22
  v_xor_b32 v25, v25, v8
  v_lshlrev_b32 v59, 4, v25
  v_mov_b32 v60, v10
  v_lshl_add_u32 v7, v10, 10, v59
  v_lshlrev_b32 v22, 5, v22
  v_lshl_add_u32 v22, v14, 3, v22
  v_bfe_u32 v23, v1, 2, 2
  v_xor_b32 v25, 2, v23
  v_lshlrev_b32 v27, 12, v24
  v_lshl_add_u32 v27, v23, 8, v27
  v_add_u32 v27, v27, v22
  v_add_u32 v27, 2048, v27
  v_lshl_add_u32 v28, v25, 6, v27
  v_and_b32 v46, 1, v9
  v_lshrrev_b32 v47, 1, v9
  v_lshl_add_u32 v46, v46, 1, v47
  v_lshl_add_u32 v46, v8, 3, v46
  s_lshl_b32 s86, s56, 8
  s_add_u32 s86, s86, 159744
  v_lshl_add_u32 v46, v46, 2, s86
  v_and_b32 v27, 15, v1
  v_lshl_add_u32 v26, v27, 7, v26
  s_lshl_b32 s86, s60, 13
  v_add_u32 v26, s86, v26
  v_bfe_u32 v27, v1, 1, 3
  v_xor_b32 v27, v27, v24
  v_lshl_add_u32 v29, v27, 4, v26
  s_and_b32 s86, s2, 6
  s_lshr_b32 s87, s2, 3
  s_lshl_b32 s66, s86, 1
  s_and_b32 s86, s87, 3
  s_add_u32 s66, s66, s86
  s_bfe_u32 s67, s87, 0x10002
  s_lshr_b32 s68, s87, 3
  s_and_b32 s86, s2, 1
  s_lshl_b32 s86, s86, 2
  s_add_u32 s68, s68, s86
  s_lshl_b32 s70, s58, 7
  s_lshl_b32 s86, s57, 2
  s_add_u32 s86, s86, s60
  s_mul_i32 s77, s86, 147456
  s_lshr_b32 s86, s86, 1
  s_lshl_b32 s86, s86, 3
  s_lshr_b32 s87, s58, 1
  s_add_u32 s86, s86, s87
  s_lshl_b32 s86, s86, 7
  s_and_b32 s87, s58, 1
  s_lshl_b32 s87, s87, 4
  s_add_u32 s86, s86, s87
  s_and_b32 s87, s60, 1
  s_lshl_b32 s87, s87, 3
  s_add_u32 s86, s86, s87
  s_add_u32 m0, s65, 2048
  s_add_u32 s80, s86, 10698756
  buffer_load_dwordx4 v4, s[36:39], s64 offen lds
  s_add_u32 m0, s65, 0
  s_nop 0
  buffer_load_dwordx4 v2, s[32:35], s63 offen lds
  s_add_u32 m0, s65, 3072
  s_add_u32 s64, s64, s3
  buffer_load_dwordx4 v4, s[36:39], s64 offen lds
  s_add_u32 m0, s65, 1024
  s_nop 0
  buffer_load_dwordx4 v3, s[32:35], s63 offen lds
  s_mov_b32 s44, s20
  s_mov_b32 s45, s21
  s_mov_b32 s46, 1835008
  s_mul_i32 s65, s60, 458752
  s_mul_i32 s86, s68, 128
  s_add_u32 s65, s65, s86
  s_add_u32 s65, s65, 0
  s_mul_i32 s64, s60, 6144
  s_add_u32 s64, s64, 107520
  v_lshl_add_u32 v61, v24, 2, v23
  v_lshl_add_u32 v61, v61, 7, v22
  v_lshrrev_b32 v60, 1, v23
  v_lshl_add_u32 v61, v60, 6, v61
  v_add_u32 v4, s64, v61
  v_xor_b32 v5, 64, v4
  v_add_u32 v3, 147456, v15
  s_lshl_b32 s86, s66, 1
  s_add_u32 s86, s86, s67
  s_lshl_b32 s90, s86, 10
  s_mul_i32 s101, s68, 0
  s_add_u32 s101, s101, s86
  s_mul_i32 s63, s86, 294912
  s_mul_i32 s86, s60, 28672
  s_add_u32 s63, s63, s86
  s_add_u32 s63, s63, 32768
  s_lshl_b32 s86, s60, 7
  s_add_u32 s90, s90, s86
  s_add_u32 s90, s90, 10699264
  v_lshl_add_u32 v59, v24, 2, s60
  v_and_b32 v127, 31, v1
  v_lshrrev_b32 v126, 1, v59
  v_add_u32 v126, 1, v126
  v_cmp_gt_u32 vcc, 3, v126
  v_and_b32 v125, 1, v59
  v_lshl_add_u32 v125, v125, 5, v127
  v_cndmask_b32 v126, 0, v126, vcc
  s_lshl_b32 s87, s58, 6
  v_lshl_add_u32 v126, v126, 9, v125
  v_add_lshl_u32 v124, v126, s87, 3
  v_mov_b32 v122, 0
  s_lshl_b32 s88, s57, 2
  s_add_u32 s88, s88, s60
  s_lshl_b32 s88, s88, 5
  v_add_lshl_u32 v125, v127, s88, 3
  v_lshlrev_b32 v59, 8, v59
  v_lshl_add_u32 v59, v127, 3, v59
  v_add_u32 v59, 159744, v59
  s_lshl_b32 s88, s60, 7
  s_add_u32 s88, s88, 161792
  v_lshl_add_u32 v58, v127, 2, s88
  v_and_b32 v96, 31, v1
  s_lshl_b32 s86, s60, 5
  s_add_u32 s86, s86, 16
  v_add_u32 v96, s86, v96
  v_mul_u32_u24 v96, 144, v96
  v_lshl_add_u32 v96, v24, 5, v96
  v_add_u32 v96, 86272, v96
  s_lshl_b32 s87, s57, 3
  s_add_u32 s87, s87, s58
  s_lshl_b32 s72, s87, 13
  s_add_u32 s72, s72, 10752000
  s_lshl_b32 s83, s87, 7
  s_add_u32 s83, s83, 10682372
  v_and_b32 v97, 15, v1
  v_mul_u32_u24 v97, 144, v97
  v_lshl_add_u32 v97, v24, 5, v97
  v_and_b32 v98, 16, v1
  v_cmp_ne_u32 vcc, 0, v98
  v_mov_b32 v98, 2146435072
  s_cmp_eq_u32 s60, 3
  s_cselect_b32 s72, s72, 2146435072
  s_cselect_b32 s83, s83, 2146435072
  v_cndmask_b32 v97, v98, v97, vcc
  v_mov_b32 v12, v28
  v_xor_b32 v13, 64, v28
  v_mov_b32 v8, v29
  v_xor_b32 v9, 32, v29
  v_xor_b32 v10, 64, v29
  v_xor_b32 v11, 96, v29
  s_waitcnt vmcnt(6)
  v_dot2_f32_bf16 v44, v32, s74, 0
  v_dot2_f32_bf16 v45, v32, v32, 0
  v_dot2_f32_bf16 v44, v33, s74, v44
  v_dot2_f32_bf16 v45, v33, v33, v45
  v_dot2_f32_bf16 v44, v34, s74, v44
  v_dot2_f32_bf16 v45, v34, v34, v45
  v_dot2_f32_bf16 v44, v35, s74, v44
  v_dot2_f32_bf16 v45, v35, v35, v45
  s_waitcnt vmcnt(4)
  v_dot2_f32_bf16 v48, v36, s75, 0
  v_dot2_f32_bf16 v49, v36, s76, 0
  v_dot2_f32_bf16 v50, v37, s75, 0
  v_dot2_f32_bf16 v51, v37, s76, 0
  v_dot2_f32_bf16 v52, v38, s75, 0
  v_dot2_f32_bf16 v53, v38, s76, 0
  v_dot2_f32_bf16 v54, v39, s75, 0
  v_dot2_f32_bf16 v55, v39, s76, 0
  v_dot2_f32_bf16 v48, v40, s75, v48
  v_dot2_f32_bf16 v49, v40, s76, v49
  v_dot2_f32_bf16 v50, v41, s75, v50
  v_dot2_f32_bf16 v51, v41, s76, v51
  v_dot2_f32_bf16 v52, v42, s75, v52
  v_dot2_f32_bf16 v53, v42, s76, v53
  v_dot2_f32_bf16 v54, v43, s75, v54
  v_dot2_f32_bf16 v55, v43, s76, v55
  v_permlane32_swap_b32 v44, v45
  v_permlane32_swap_b32 v48, v49
  v_permlane32_swap_b32 v50, v51
  v_permlane32_swap_b32 v52, v53
  v_permlane32_swap_b32 v54, v55
  v_add_f32 v56, v44, v45
  v_add_f32 v48, v48, v49
  v_add_f32 v50, v50, v51
  v_add_f32 v52, v52, v53
  v_add_f32 v54, v54, v55
  v_mov_b32 v57, v56
  v_permlane16_swap_b32 v48, v50
  v_permlane16_swap_b32 v52, v54
  v_add_f32 v48, v48, v50
  v_add_f32 v52, v52, v54
  v_permlane16_swap_b32 v56, v57
  v_add_f32_dpp v48, v48, v48 row_ror:8 row_mask:0xf bank_mask:0xf
  v_add_f32_dpp v52, v52, v52 row_ror:8 row_mask:0xf bank_mask:0xf
  v_add_f32 v56, v56, v57
  ds_write2_b32 v46, v48, v52 offset0:0 offset1:4
  s_waitcnt lgkmcnt(0)
  s_mul_i32 s59, s73, 0x9E3779B1
  s_add_u32 s59, s59, 0x7F4A7C15
  s_and_b32 s59, s59, 0xfffffffc
  s_barrier
  v_lshlrev_b32 v57, 2, v1
  v_add_u32 v57, 159744, v57
  ds_read2st64_b32 v[48:49], v57 offset0:0 offset1:1
  ds_read2st64_b32 v[50:51], v57 offset0:2 offset1:3
  ds_read2st64_b32 v[52:53], v57 offset0:4 offset1:5
  ds_read2st64_b32 v[54:55], v57 offset0:6 offset1:7
  v_add_f32_dpp v56, v56, v56 row_ror:8 row_mask:0xf bank_mask:0xf
  s_nop 1
  v_add_f32_dpp v56, v56, v56 row_ror:4 row_mask:0xf bank_mask:0xf
  s_lshl_b32 s88, s98, 3
  s_nop 0
  v_add_f32_dpp v56, v56, v56 row_ror:2 row_mask:0xf bank_mask:0xf
  s_add_u32 s88, s88, 10485760
  v_mov_b32 v117, s59
  v_add_f32_dpp v56, v56, v56 row_ror:1 row_mask:0xf bank_mask:0xf
  v_mov_b32 v112, 0x3b000000
  v_readlane_b32 s86, v56, 0
  v_readlane_b32 s87, v56, 32
  s_nop 0
  v_mul_f32 v113, s86, v112
  v_mul_f32 v114, s87, v112
  v_fma_f32 v114, -v113, v113, v114
  v_max_f32 v114, 0, v114
  v_cvt_pk_bf16_f32 v115, v113, v114
  v_and_b32 v115, 0xffff0000, v115
  v_add_f32 v115, 0x3727c5ac, v115
  v_cvt_pk_bf16_f32 v115, v115, v115
  v_and_b32 v115, 0xffff0000, v115
  v_sqrt_f32 v115, v115
  s_nop 0
  v_cvt_pk_bf16_f32 v116, v113, v115
  s_mov_b32 s98, s88
  s_waitcnt lgkmcnt(0)
  v_add_f32 v48, v48, v49
  v_add_f32 v50, v50, v51
  v_add_f32 v52, v52, v53
  v_add_f32 v54, v54, v55
  v_add_f32 v48, v48, v50
  s_lshl_b32 s86, s99, 9
  v_add_f32 v52, v52, v54
  s_mul_i32 s87, s100, 26624
  s_add_u32 s86, s86, s87
  s_add_u32 s86, s86, 10551296
  v_add_f32 v118, v48, v52
  v_mov_b32 v119, s59
  v_lshlrev_b32 v57, 3, v1
  s_cmp_eq_u32 s60, 0
  s_cselect_b32 s86, s86, 2146435072
  s_cmp_ge_u32 s99, 52
  s_cselect_b32 s86, 2146435072, s86
  s_mov_b32 s99, s86
  s_waitcnt vmcnt(0)
  s_barrier
  ds_read_b64_tr_b16 v[32:33], v12 offset:0
  ds_read_b64_tr_b16 v[34:35], v12 offset:1024
  ds_read_b128 v[224:227], v8 offset:0
  ds_read_b64_tr_b16 v[36:37], v13 offset:0
  ds_read_b64_tr_b16 v[38:39], v13 offset:1024
  s_waitcnt lgkmcnt(0)
  v_mfma_f32_32x32x16_bf16 v[64:79], v[32:35], v[224:227], 0
  ds_read_b64_tr_b16 v[40:41], v12 offset:8192
  ds_read_b64_tr_b16 v[42:43], v12 offset:9216
  ds_read_b128 v[228:231], v9 offset:0
  ds_read_b64_tr_b16 v[44:45], v13 offset:8192
  ds_read_b64_tr_b16 v[46:47], v13 offset:9216
  v_mfma_f32_32x32x16_bf16 v[80:95], v[36:39], v[224:227], 0
  s_mov_b64 exec, 1
  buffer_store_dwordx2 v[116:117], off, s[40:43], s98 sc1
  s_mov_b64 exec, -1
  buffer_store_dwordx2 v[118:119], v57, s[40:43], s99 offen sc1
  s_waitcnt lgkmcnt(0)
  v_mfma_f32_32x32x16_bf16 v[64:79], v[40:43], v[228:231], v[64:79]
  ds_read_b64_tr_b16 v[32:33], v12 offset:16384
  ds_read_b64_tr_b16 v[34:35], v12 offset:17408
  ds_read_b128 v[224:227], v10 offset:0
  ds_read_b64_tr_b16 v[36:37], v13 offset:16384
  ds_read_b64_tr_b16 v[38:39], v13 offset:17408
  v_mfma_f32_32x32x16_bf16 v[80:95], v[44:47], v[228:231], v[80:95]
  s_waitcnt lgkmcnt(0)
  v_mfma_f32_32x32x16_bf16 v[64:79], v[32:35], v[224:227], v[64:79]
  ds_read_b64_tr_b16 v[40:41], v12 offset:24576
  ds_read_b64_tr_b16 v[42:43], v12 offset:25600
  ds_read_b128 v[228:231], v11 offset:0
  ds_read_b64_tr_b16 v[44:45], v13 offset:24576
  ds_read_b64_tr_b16 v[46:47], v13 offset:25600
  v_mfma_f32_32x32x16_bf16 v[80:95], v[36:39], v[224:227], v[80:95]
  s_barrier
  s_waitcnt lgkmcnt(0)
  v_mfma_f32_32x32x16_bf16 v[64:79], v[40:43], v[228:231], v[64:79]
  ds_read_b64_tr_b16 v[32:33], v12 offset:32768
  ds_read_b64_tr_b16 v[34:35], v12 offset:33792
  ds_read_b128 v[224:227], v8 offset:32768
  ds_read_b64_tr_b16 v[36:37], v13 offset:32768
  ds_read_b64_tr_b16 v[38:39], v13 offset:33792
  v_mfma_f32_32x32x16_bf16 v[80:95], v[44:47], v[228:231], v[80:95]
  s_waitcnt lgkmcnt(0)
  v_mfma_f32_32x32x16_bf16 v[64:79], v[32:35], v[224:227], v[64:79]
  ds_read_b64_tr_b16 v[40:41], v12 offset:40960
  ds_read_b64_tr_b16 v[42:43], v12 offset:41984
  ds_read_b128 v[228:231], v9 offset:32768
  ds_read_b64_tr_b16 v[44:45], v13 offset:40960
  ds_read_b64_tr_b16 v[46:47], v13 offset:41984
  v_mfma_f32_32x32x16_bf16 v[80:95], v[36:39], v[224:227], v[80:95]
  s_waitcnt lgkmcnt(0)
  v_mfma_f32_32x32x16_bf16 v[64:79], v[40:43], v[228:231], v[64:79]
  ds_read_b64_tr_b16 v[32:33], v12 offset:49152
  ds_read_b64_tr_b16 v[34:35], v12 offset:50176
  ds_read_b128 v[224:227], v10 offset:32768
  ds_read_b64_tr_b16 v[36:37], v13 offset:49152
  ds_read_b64_tr_b16 v[38:39], v13 offset:50176
  v_mfma_f32_32x32x16_bf16 v[80:95], v[44:47], v[228:231], v[80:95]
  s_waitcnt lgkmcnt(0)
  v_mfma_f32_32x32x16_bf16 v[64:79], v[32:35], v[224:227], v[64:79]
  ds_read_b64_tr_b16 v[40:41], v12 offset:57344
  ds_read_b64_tr_b16 v[42:43], v12 offset:58368
  ds_read_b128 v[228:231], v11 offset:32768
  ds_read_b64_tr_b16 v[44:45], v13 offset:57344
  ds_read_b64_tr_b16 v[46:47], v13 offset:58368
  v_mfma_f32_32x32x16_bf16 v[80:95], v[36:39], v[224:227], v[80:95]
  s_barrier
  s_waitcnt lgkmcnt(0)
  v_mfma_f32_32x32x16_bf16 v[64:79], v[40:43], v[228:231], v[64:79]
  v_xor_b32 v8, 0x10000, v8
  v_xor_b32 v9, 0x10000, v9
  v_xor_b32 v10, 0x10000, v10
  v_xor_b32 v11, 0x10000, v11
  v_xor_b32 v12, 0x10000, v12
  v_xor_b32 v13, 0x10000, v13
  ds_read_b64_tr_b16 v[32:33], v12 offset:0
  ds_read_b64_tr_b16 v[34:35], v12 offset:1024
  ds_read_b128 v[224:227], v8 offset:0
  ds_read_b64_tr_b16 v[36:37], v13 offset:0
  ds_read_b64_tr_b16 v[38:39], v13 offset:1024
  v_mfma_f32_32x32x16_bf16 v[80:95], v[44:47], v[228:231], v[80:95]
  s_waitcnt lgkmcnt(0)
  v_mfma_f32_32x32x16_bf16 v[64:79], v[32:35], v[224:227], v[64:79]
  ds_read_b64_tr_b16 v[40:41], v12 offset:8192
  ds_read_b64_tr_b16 v[42:43], v12 offset:9216
  ds_read_b128 v[228:231], v9 offset:0
  ds_read_b64_tr_b16 v[44:45], v13 offset:8192
  ds_read_b64_tr_b16 v[46:47], v13 offset:9216
  v_mfma_f32_32x32x16_bf16 v[80:95], v[36:39], v[224:227], v[80:95]
  s_waitcnt lgkmcnt(0)
  v_mfma_f32_32x32x16_bf16 v[64:79], v[40:43], v[228:231], v[64:79]
  ds_read_b64_tr_b16 v[32:33], v12 offset:16384
  ds_read_b64_tr_b16 v[34:35], v12 offset:17408
  ds_read_b128 v[224:227], v10 offset:0
  ds_read_b64_tr_b16 v[36:37], v13 offset:16384
  ds_read_b64_tr_b16 v[38:39], v13 offset:17408
  v_mfma_f32_32x32x16_bf16 v[80:95], v[44:47], v[228:231], v[80:95]
  s_mov_b32 s86, 10551296
  buffer_load_dwordx2 v[112:113], v124, s[40:43], s86 offen sc1
  s_waitcnt lgkmcnt(0)
  v_mfma_f32_32x32x16_bf16 v[64:79], v[32:35], v[224:227], v[64:79]
  ds_read_b64_tr_b16 v[40:41], v12 offset:24576
  ds_read_b64_tr_b16 v[42:43], v12 offset:25600
  ds_read_b128 v[228:231], v11 offset:0
  ds_read_b64_tr_b16 v[44:45], v13 offset:24576
  ds_read_b64_tr_b16 v[46:47], v13 offset:25600
  v_mfma_f32_32x32x16_bf16 v[80:95], v[36:39], v[224:227], v[80:95]
  s_mov_b32 s86, 10577920
  buffer_load_dwordx2 v[114:115], v124, s[40:43], s86 offen sc1
  s_barrier
  s_waitcnt lgkmcnt(0)
  v_mfma_f32_32x32x16_bf16 v[64:79], v[40:43], v[228:231], v[64:79]
  ds_read_b64_tr_b16 v[32:33], v12 offset:32768
  ds_read_b64_tr_b16 v[34:35], v12 offset:33792
  ds_read_b128 v[224:227], v8 offset:32768
  ds_read_b64_tr_b16 v[36:37], v13 offset:32768
  ds_read_b64_tr_b16 v[38:39], v13 offset:33792
  v_mfma_f32_32x32x16_bf16 v[80:95], v[44:47], v[228:231], v[80:95]
  s_mov_b32 s86, 10604544
  buffer_load_dwordx2 v[116:117], v124, s[40:43], s86 offen sc1
  s_waitcnt lgkmcnt(0)
  v_mfma_f32_32x32x16_bf16 v[64:79], v[32:35], v[224:227], v[64:79]
  ds_read_b64_tr_b16 v[40:41], v12 offset:40960
  ds_read_b64_tr_b16 v[42:43], v12 offset:41984
  ds_read_b128 v[228:231], v9 offset:32768
  ds_read_b64_tr_b16 v[44:45], v13 offset:40960
  ds_read_b64_tr_b16 v[46:47], v13 offset:41984
  v_mfma_f32_32x32x16_bf16 v[80:95], v[36:39], v[224:227], v[80:95]
  s_mov_b32 s86, 10631168
  buffer_load_dwordx2 v[118:119], v124, s[40:43], s86 offen sc1
  s_waitcnt lgkmcnt(0)
  v_mfma_f32_32x32x16_bf16 v[64:79], v[40:43], v[228:231], v[64:79]
  ds_read_b64_tr_b16 v[32:33], v12 offset:49152
  ds_read_b64_tr_b16 v[34:35], v12 offset:50176
  ds_read_b128 v[224:227], v10 offset:32768
  ds_read_b64_tr_b16 v[36:37], v13 offset:49152
  ds_read_b64_tr_b16 v[38:39], v13 offset:50176
  v_mfma_f32_32x32x16_bf16 v[80:95], v[44:47], v[228:231], v[80:95]
  s_mov_b32 s86, 10485760
  buffer_load_dwordx2 v[120:121], v125, s[40:43], s86 offen sc1
  s_mov_b32 s52, s20
  s_mov_b32 s53, s21
  s_mov_b32 s54, 1835008
  s_mov_b32 s55, 0x20000
  v_and_b32 v61, 3, v1
  v_lshlrev_b32 v61, 7, v61
  v_bfe_u32 v60, v1, 2, 4
  v_lshl_add_u32 v61, v60, 10, v61
  s_bfe_u32 s84, s2, 0x40003
  s_lshl_b32 s84, s84, 2
  s_add_u32 s84, s84, s60
  s_mul_i32 s5, s84, 28672
  s_and_b32 s84, s2, 1
  s_lshl_b32 s84, s84, 9
  s_add_u32 s5, s5, s84
  buffer_load_dword v240, v61, s[52:55], s5 offen
  s_waitcnt lgkmcnt(0)
  v_mfma_f32_32x32x16_bf16 v[64:79], v[32:35], v[224:227], v[64:79]
  ds_read_b64_tr_b16 v[40:41], v12 offset:57344
  ds_read_b64_tr_b16 v[42:43], v12 offset:58368
  ds_read_b128 v[228:231], v11 offset:32768
  ds_read_b64_tr_b16 v[44:45], v13 offset:57344
  ds_read_b64_tr_b16 v[46:47], v13 offset:58368
  v_mfma_f32_32x32x16_bf16 v[80:95], v[36:39], v[224:227], v[80:95]
  s_barrier
  s_waitcnt lgkmcnt(0)
  v_mfma_f32_32x32x16_bf16 v[64:79], v[40:43], v[228:231], v[64:79]
  v_xor_b32 v8, 0x10000, v8
  v_xor_b32 v9, 0x10000, v9
  v_xor_b32 v10, 0x10000, v10
  v_xor_b32 v11, 0x10000, v11
  v_xor_b32 v12, 0x10000, v12
  v_xor_b32 v13, 0x10000, v13
  ds_read_b64_tr_b16 v[32:33], v12 offset:0
  ds_read_b64_tr_b16 v[34:35], v12 offset:1024
  ds_read_b128 v[224:227], v8 offset:0
  ds_read_b64_tr_b16 v[36:37], v13 offset:0
  ds_read_b64_tr_b16 v[38:39], v13 offset:1024
  v_mfma_f32_32x32x16_bf16 v[80:95], v[44:47], v[228:231], v[80:95]
  s_waitcnt lgkmcnt(0)
  v_mfma_f32_32x32x16_bf16 v[64:79], v[32:35], v[224:227], v[64:79]
  ds_read_b64_tr_b16 v[40:41], v12 offset:8192
  ds_read_b64_tr_b16 v[42:43], v12 offset:9216
  ds_read_b128 v[228:231], v9 offset:0
  ds_read_b64_tr_b16 v[44:45], v13 offset:8192
  ds_read_b64_tr_b16 v[46:47], v13 offset:9216
  v_mfma_f32_32x32x16_bf16 v[80:95], v[36:39], v[224:227], v[80:95]
  s_waitcnt lgkmcnt(0)
  v_mfma_f32_32x32x16_bf16 v[64:79], v[40:43], v[228:231], v[64:79]
  ds_read_b64_tr_b16 v[32:33], v12 offset:16384
  ds_read_b64_tr_b16 v[34:35], v12 offset:17408
  ds_read_b128 v[224:227], v10 offset:0
  ds_read_b64_tr_b16 v[36:37], v13 offset:16384
  ds_read_b64_tr_b16 v[38:39], v13 offset:17408
  v_mfma_f32_32x32x16_bf16 v[80:95], v[44:47], v[228:231], v[80:95]
  s_add_u32 s5, s5, 12288
  buffer_load_dword v241, v61, s[52:55], s5 offen
  s_waitcnt lgkmcnt(0)
  v_mfma_f32_32x32x16_bf16 v[64:79], v[32:35], v[224:227], v[64:79]
  ds_read_b64_tr_b16 v[40:41], v12 offset:24576
  ds_read_b64_tr_b16 v[42:43], v12 offset:25600
  ds_read_b128 v[228:231], v11 offset:0
  ds_read_b64_tr_b16 v[44:45], v13 offset:24576
  ds_read_b64_tr_b16 v[46:47], v13 offset:25600
  v_mfma_f32_32x32x16_bf16 v[80:95], v[36:39], v[224:227], v[80:95]
  s_barrier
  s_waitcnt lgkmcnt(0)
  v_mfma_f32_32x32x16_bf16 v[64:79], v[40:43], v[228:231], v[64:79]
  ds_read_b64_tr_b16 v[32:33], v12 offset:32768
  ds_read_b64_tr_b16 v[34:35], v12 offset:33792
  ds_read_b128 v[224:227], v8 offset:32768
  ds_read_b64_tr_b16 v[36:37], v13 offset:32768
  ds_read_b64_tr_b16 v[38:39], v13 offset:33792
  v_mfma_f32_32x32x16_bf16 v[80:95], v[44:47], v[228:231], v[80:95]
  s_waitcnt lgkmcnt(0)
  v_mfma_f32_32x32x16_bf16 v[64:79], v[32:35], v[224:227], v[64:79]
  ds_read_b64_tr_b16 v[40:41], v12 offset:40960
  ds_read_b64_tr_b16 v[42:43], v12 offset:41984
  ds_read_b128 v[228:231], v9 offset:32768
  ds_read_b64_tr_b16 v[44:45], v13 offset:40960
  ds_read_b64_tr_b16 v[46:47], v13 offset:41984
  v_mfma_f32_32x32x16_bf16 v[80:95], v[36:39], v[224:227], v[80:95]
  s_waitcnt vmcnt(2)
  v_xor_b32 v126, s59, v113
  v_xor_b32 v127, s59, v115
  v_xor_b32 v123, s59, v117
  v_or3_b32 v126, v126, v127, v123
  v_xor_b32 v127, s59, v119
  v_xor_b32 v123, s59, v121
  v_or3_b32 v126, v126, v127, v123
  v_cmp_ne_u32 vcc, 0, v126
  s_cbranch_vccz L_gok_26
  s_mov_b32 s89, 0
L_gspin_27:
  s_sleep 2
  s_mov_b32 s86, 10551296
  buffer_load_dwordx2 v[112:113], v124, s[40:43], s86 offen sc1
  s_mov_b32 s86, 10577920
  buffer_load_dwordx2 v[114:115], v124, s[40:43], s86 offen sc1
  s_mov_b32 s86, 10604544
  buffer_load_dwordx2 v[116:117], v124, s[40:43], s86 offen sc1
  s_mov_b32 s86, 10631168
  buffer_load_dwordx2 v[118:119], v124, s[40:43], s86 offen sc1
  s_mov_b32 s86, 10485760
  buffer_load_dwordx2 v[120:121], v125, s[40:43], s86 offen sc1
  s_waitcnt vmcnt(0)
  v_xor_b32 v126, s59, v113
  v_xor_b32 v127, s59, v115
  v_xor_b32 v123, s59, v117
  v_or3_b32 v126, v126, v127, v123
  v_xor_b32 v127, s59, v119
  v_xor_b32 v123, s59, v121
  v_or3_b32 v126, v126, v127, v123
  v_cmp_ne_u32 vcc, 0, v126
  s_cbranch_vccz L_gok_26
  s_add_u32 s89, s89, 1
  s_cmp_lt_u32 s89, 0x8000
  s_cbranch_scc1 L_gspin_27
L_gok_26:
  s_nop 0
  s_waitcnt lgkmcnt(0)
  v_mfma_f32_32x32x16_bf16 v[64:79], v[40:43], v[228:231], v[64:79]
  ds_read_b64_tr_b16 v[32:33], v12 offset:49152
  ds_read_b64_tr_b16 v[34:35], v12 offset:50176
  ds_read_b128 v[224:227], v10 offset:32768
  ds_read_b64_tr_b16 v[36:37], v13 offset:49152
  ds_read_b64_tr_b16 v[38:39], v13 offset:50176
  v_mfma_f32_32x32x16_bf16 v[80:95], v[44:47], v[228:231], v[80:95]
  ds_write_b32 v58, v120
  v_add_f32 v112, v112, v114
  v_add_f32 v116, v116, v118
  v_mov_b32 v126, 0
  s_waitcnt lgkmcnt(1)
  v_mfma_f32_32x32x16_bf16 v[64:79], v[32:35], v[224:227], v[64:79]
  ds_read_b64_tr_b16 v[40:41], v12 offset:57344
  ds_read_b64_tr_b16 v[42:43], v12 offset:58368
  ds_read_b128 v[228:231], v11 offset:32768
  ds_read_b64_tr_b16 v[44:45], v13 offset:57344
  ds_read_b64_tr_b16 v[46:47], v13 offset:58368
  v_mfma_f32_32x32x16_bf16 v[80:95], v[36:39], v[224:227], v[80:95]
  v_add_f32 v112, v112, v116
  v_mov_b32 v127, 162304
  v_cvt_pk_bf16_f32 v113, v112, v112
  ds_write_b32 v127, v126
  s_barrier
  s_waitcnt lgkmcnt(1)
  v_mfma_f32_32x32x16_bf16 v[64:79], v[40:43], v[228:231], v[64:79]
  v_xor_b32 v8, 0x10000, v8
  v_xor_b32 v9, 0x10000, v9
  v_xor_b32 v10, 0x10000, v10
  v_xor_b32 v11, 0x10000, v11
  v_xor_b32 v12, 0x10000, v12
  v_xor_b32 v13, 0x10000, v13
  ds_read_b64_tr_b16 v[32:33], v12 offset:0
  ds_read_b64_tr_b16 v[34:35], v12 offset:1024
  ds_read_b128 v[224:227], v8 offset:0
  ds_read_b64_tr_b16 v[36:37], v13 offset:0
  ds_read_b64_tr_b16 v[38:39], v13 offset:1024
  v_mfma_f32_32x32x16_bf16 v[80:95], v[44:47], v[228:231], v[80:95]
  v_and_b32 v114, 0xffff0000, v113
  v_sub_f32 v112, v112, v114
  v_and_b32 v113, 0xffff, v113
  v_cvt_pk_bf16_f32 v114, v112, v112
  s_waitcnt lgkmcnt(0)
  v_mfma_f32_32x32x16_bf16 v[64:79], v[32:35], v[224:227], v[64:79]
  ds_read_b64_tr_b16 v[40:41], v12 offset:8192
  ds_read_b64_tr_b16 v[42:43], v12 offset:9216
  ds_read_b128 v[228:231], v9 offset:0
  ds_read_b64_tr_b16 v[44:45], v13 offset:8192
  ds_read_b64_tr_b16 v[46:47], v13 offset:9216
  v_mfma_f32_32x32x16_bf16 v[80:95], v[36:39], v[224:227], v[80:95]
  v_and_b32 v115, 0xffff0000, v114
  v_sub_f32 v112, v112, v115
  v_or_b32 v114, v113, v115
  v_cvt_pk_bf16_f32 v116, v112, 0
  s_waitcnt lgkmcnt(0)
  v_mfma_f32_32x32x16_bf16 v[64:79], v[40:43], v[228:231], v[64:79]
  ds_read_b64_tr_b16 v[32:33], v12 offset:16384
  ds_read_b64_tr_b16 v[34:35], v12 offset:17408
  ds_read_b128 v[224:227], v10 offset:0
  ds_read_b64_tr_b16 v[36:37], v13 offset:16384
  ds_read_b64_tr_b16 v[38:39], v13 offset:17408
  v_mfma_f32_32x32x16_bf16 v[80:95], v[44:47], v[228:231], v[80:95]
  v_lshl_or_b32 v115, v122, 16, v116
  ds_write_b64 v59, v[114:115]
  v_cmp_gt_u32 vcc, 32, v1
  v_xor_b32 v120, 0x8000, v120
  s_waitcnt lgkmcnt(1)
  v_mfma_f32_32x32x16_bf16 v[64:79], v[32:35], v[224:227], v[64:79]
  ds_read_b64_tr_b16 v[40:41], v12 offset:24576
  ds_read_b64_tr_b16 v[42:43], v12 offset:25600
  ds_read_b128 v[228:231], v11 offset:0
  ds_read_b64_tr_b16 v[44:45], v13 offset:24576
  ds_read_b64_tr_b16 v[46:47], v13 offset:25600
  v_mfma_f32_32x32x16_bf16 v[80:95], v[36:39], v[224:227], v[80:95]
  v_and_b32 v121, 0xffff, v120
  v_lshl_or_b32 v121, v121, 16, v121
  v_cndmask_b32 v16, 0, v121, vcc
  v_cndmask_b32 v17, 0, v120, vcc
  s_barrier
  s_waitcnt lgkmcnt(0)
  v_mfma_f32_32x32x16_bf16 v[64:79], v[40:43], v[228:231], v[64:79]
  ds_read_b64_tr_b16 v[32:33], v12 offset:32768
  ds_read_b64_tr_b16 v[34:35], v12 offset:33792
  ds_read_b128 v[224:227], v8 offset:32768
  ds_read_b64_tr_b16 v[36:37], v13 offset:32768
  ds_read_b64_tr_b16 v[38:39], v13 offset:33792
  v_mfma_f32_32x32x16_bf16 v[80:95], v[44:47], v[228:231], v[80:95]
  v_and_b32 v121, 0xffff0000, v120
  v_mov_b32 v18, 0
  v_mov_b32 v19, 0
  v_rcp_f32 v20, v121
  s_waitcnt lgkmcnt(0)
  v_mfma_f32_32x32x16_bf16 v[64:79], v[32:35], v[224:227], v[64:79]
  ds_read_b64_tr_b16 v[40:41], v12 offset:40960
  ds_read_b64_tr_b16 v[42:43], v12 offset:41984
  ds_read_b128 v[228:231], v9 offset:32768
  ds_read_b64_tr_b16 v[44:45], v13 offset:40960
  ds_read_b64_tr_b16 v[46:47], v13 offset:41984
  v_mfma_f32_32x32x16_bf16 v[80:95], v[36:39], v[224:227], v[80:95]
  s_waitcnt lgkmcnt(0)
  v_mfma_f32_32x32x16_bf16 v[64:79], v[40:43], v[228:231], v[64:79]
  ds_read_b64_tr_b16 v[32:33], v12 offset:49152
  ds_read_b64_tr_b16 v[34:35], v12 offset:50176
  ds_read_b128 v[224:227], v10 offset:32768
  ds_read_b64_tr_b16 v[36:37], v13 offset:49152
  ds_read_b64_tr_b16 v[38:39], v13 offset:50176
  v_mfma_f32_32x32x16_bf16 v[80:95], v[44:47], v[228:231], v[80:95]
  s_waitcnt lgkmcnt(0)
  v_mfma_f32_32x32x16_bf16 v[64:79], v[32:35], v[224:227], v[64:79]
  ds_read_b64_tr_b16 v[40:41], v12 offset:57344
  ds_read_b64_tr_b16 v[42:43], v12 offset:58368
  ds_read_b128 v[228:231], v11 offset:32768
  ds_read_b64_tr_b16 v[44:45], v13 offset:57344
  ds_read_b64_tr_b16 v[46:47], v13 offset:58368
  v_mfma_f32_32x32x16_bf16 v[80:95], v[36:39], v[224:227], v[80:95]
  s_barrier
  v_and_b32 v126, 31, v1
  v_lshlrev_b32 v127, 3, v126
  v_add_u32 v127, 159744, v127
  v_mov_b32 v24, 0
  v_mov_b32 v25, 0
  v_mov_b32 v28, 0
  v_mov_b32 v29, 0
  ds_read_b64 v[22:23], v127 offset:512
  ds_read_b64 v[26:27], v127 offset:768
  s_waitcnt lgkmcnt(2)
  v_mfma_f32_32x32x16_bf16 v[64:79], v[40:43], v[228:231], v[64:79]
  v_mfma_f32_32x32x16_bf16 v[80:95], v[44:47], v[228:231], v[80:95]
  s_waitcnt lgkmcnt(0)
  v_mfma_f32_32x32x16_bf16 v[64:79], v[22:25], v[16:19], v[64:79]
  v_mfma_f32_32x32x16_bf16 v[80:95], v[26:29], v[16:19], v[80:95]
  s_barrier
  s_add_u32 m0, s64, 0
  s_add_u32 s5, s65, 0
  buffer_load_dwordx4 v7, s[44:47], s5 offen lds
  s_add_u32 m0, s64, 1024
  s_add_u32 s5, s5, 8192
  buffer_load_dwordx4 v7, s[44:47], s5 offen lds
  s_add_u32 m0, s64, 2048
  s_add_u32 s5, s65, 16384
  buffer_load_dwordx4 v7, s[44:47], s5 offen lds
  s_add_u32 m0, s64, 3072
  s_add_u32 s5, s5, 8192
  buffer_load_dwordx4 v7, s[44:47], s5 offen lds
  s_add_u32 m0, s64, 4096
  s_add_u32 s5, s65, 32768
  buffer_load_dwordx4 v7, s[44:47], s5 offen lds
  s_add_u32 m0, s64, 5120
  s_add_u32 s5, s5, 8192
  buffer_load_dwordx4 v7, s[44:47], s5 offen lds
  s_add_u32 m0, s64, 24576
  s_add_u32 s5, s65, 49152
  buffer_load_dwordx4 v7, s[44:47], s5 offen lds
  s_add_u32 m0, s64, 25600
  s_add_u32 s5, s5, 8192
  buffer_load_dwordx4 v7, s[44:47], s5 offen lds
  s_add_u32 m0, s64, 26624
  s_add_u32 s5, s65, 65536
  buffer_load_dwordx4 v7, s[44:47], s5 offen lds
  s_add_u32 m0, s64, 27648
  s_add_u32 s5, s5, 8192
  buffer_load_dwordx4 v7, s[44:47], s5 offen lds
  s_add_u32 m0, s64, 28672
  s_add_u32 s5, s65, 81920
  buffer_load_dwordx4 v7, s[44:47], s5 offen lds
  s_add_u32 m0, s64, 29696
  s_add_u32 s5, s5, 8192
  buffer_load_dwordx4 v7, s[44:47], s5 offen lds
  s_mov_b32 s31, s59
  v_mul_f32 v64, v64, v20
  v_mul_f32 v65, v65, v20
  v_mul_f32 v66, v66, v20
  v_mul_f32 v67, v67, v20
  v_mul_f32 v68, v68, v20
  v_mul_f32 v69, v69, v20
  v_mul_f32 v70, v70, v20
  v_mul_f32 v71, v71, v20
  v_cvt_pk_bf16_f32 v48, v64, v65
  v_cvt_pk_bf16_f32 v49, v66, v67
  v_cvt_pk_bf16_f32 v50, v68, v69
  v_cvt_pk_bf16_f32 v51, v70, v71
  ds_write_b128 v96, v[48:51] offset:0
  buffer_store_dwordx4 v[48:51], v97, s[40:43], s72 offen offset:0 sc1
  v_mul_f32 v72, v72, v20
  v_mul_f32 v73, v73, v20
  v_mul_f32 v74, v74, v20
  v_mul_f32 v75, v75, v20
  v_mul_f32 v76, v76, v20
  v_mul_f32 v77, v77, v20
  v_mul_f32 v78, v78, v20
  v_mul_f32 v79, v79, v20
  v_cvt_pk_bf16_f32 v52, v72, v73
  v_cvt_pk_bf16_f32 v53, v74, v75
  v_cvt_pk_bf16_f32 v54, v76, v77
  v_cvt_pk_bf16_f32 v55, v78, v79
  ds_write_b128 v96, v[52:55] offset:16
  buffer_store_dwordx4 v[52:55], v97, s[40:43], s72 offen offset:16 sc1
  v_mul_f32 v80, v80, v20
  v_mul_f32 v81, v81, v20
  v_mul_f32 v82, v82, v20
  v_mul_f32 v83, v83, v20
  v_mul_f32 v84, v84, v20
  v_mul_f32 v85, v85, v20
  v_mul_f32 v86, v86, v20
  v_mul_f32 v87, v87, v20
  v_cvt_pk_bf16_f32 v48, v80, v81
  v_cvt_pk_bf16_f32 v49, v82, v83
  v_cvt_pk_bf16_f32 v50, v84, v85
  v_cvt_pk_bf16_f32 v51, v86, v87
  ds_write_b128 v96, v[48:51] offset:64
  buffer_store_dwordx4 v[48:51], v97, s[40:43], s72 offen offset:64 sc1
  v_mul_f32 v88, v88, v20
  v_mul_f32 v89, v89, v20
  v_mul_f32 v90, v90, v20
  v_mul_f32 v91, v91, v20
  v_mul_f32 v92, v92, v20
  v_mul_f32 v93, v93, v20
  v_mul_f32 v94, v94, v20
  v_mul_f32 v95, v95, v20
  v_cvt_pk_bf16_f32 v52, v88, v89
  v_cvt_pk_bf16_f32 v53, v90, v91
  v_cvt_pk_bf16_f32 v54, v92, v93
  v_cvt_pk_bf16_f32 v55, v94, v95
  ds_write_b128 v96, v[52:55] offset:80
  buffer_store_dwordx4 v[52:55], v97, s[40:43], s72 offen offset:80 sc1
  s_waitcnt lgkmcnt(0)
  v_mov_b32 v62, 4096
  v_mov_b32 v21, 162304
  s_mov_b64 exec, 1
  ds_add_u32 v21, v62
  s_mov_b64 exec, -1
L_p3f:
  s_nop 1
  s_waitcnt lgkmcnt(0)
  s_and_b32 s86, s66, 1
  s_lshl_b32 s86, s86, 1
  s_add_u32 s86, s86, s67
  s_waitcnt vmcnt(10)
  ds_read_b64_tr_b16 v[128:129], v4 offset:0
  ds_read_b64_tr_b16 v[130:131], v4 offset:1024
  ds_read_b64_tr_b16 v[132:133], v5 offset:0
  ds_read_b64_tr_b16 v[134:135], v5 offset:1024
  s_waitcnt vmcnt(8)
  ds_read_b64_tr_b16 v[136:137], v4 offset:2048
  ds_read_b64_tr_b16 v[138:139], v4 offset:3072
  ds_read_b64_tr_b16 v[140:141], v5 offset:2048
  ds_read_b64_tr_b16 v[142:143], v5 offset:3072
  s_waitcnt lgkmcnt(4)
  s_add_u32 m0, s64, 0
  s_add_u32 s5, s65, 98304
  buffer_load_dwordx4 v7, s[44:47], s5 offen lds
  s_add_u32 m0, s64, 1024
  s_add_u32 s5, s5, 8192
  buffer_load_dwordx4 v7, s[44:47], s5 offen lds
  s_waitcnt vmcnt(8)
  ds_read_b64_tr_b16 v[144:145], v4 offset:4096
  ds_read_b64_tr_b16 v[146:147], v4 offset:5120
  ds_read_b64_tr_b16 v[148:149], v5 offset:4096
  ds_read_b64_tr_b16 v[150:151], v5 offset:5120
  s_waitcnt lgkmcnt(4)
  s_add_u32 m0, s64, 2048
  s_add_u32 s5, s65, 114688
  buffer_load_dwordx4 v7, s[44:47], s5 offen lds
  s_add_u32 m0, s64, 3072
  s_add_u32 s5, s5, 8192
  buffer_load_dwordx4 v7, s[44:47], s5 offen lds
  s_waitcnt vmcnt(8)
  s_waitcnt vmcnt(4)
  s_waitcnt vmcnt(4)
  v_mov_b32 v62, s31
  s_mov_b64 exec, 1
  buffer_store_dword v62, off, s[40:43], s83 sc1
  s_mov_b64 exec, -1
  ds_read_b64_tr_b16 v[152:153], v4 offset:24576
  ds_read_b64_tr_b16 v[154:155], v4 offset:25600
  ds_read_b64_tr_b16 v[156:157], v5 offset:24576
  ds_read_b64_tr_b16 v[158:159], v5 offset:25600
  s_waitcnt lgkmcnt(4)
  s_add_u32 m0, s64, 4096
  s_add_u32 s5, s65, 262144
  buffer_load_dwordx4 v7, s[44:47], s5 offen lds
  s_add_u32 m0, s64, 5120
  s_add_u32 s5, s5, 8192
  buffer_load_dwordx4 v7, s[44:47], s5 offen lds
  ds_read_b64_tr_b16 v[160:161], v4 offset:26624
  ds_read_b64_tr_b16 v[162:163], v4 offset:27648
  ds_read_b64_tr_b16 v[164:165], v5 offset:26624
  ds_read_b64_tr_b16 v[166:167], v5 offset:27648
  s_waitcnt lgkmcnt(4)
  s_add_u32 m0, s64, 24576
  s_add_u32 s5, s65, 278528
  buffer_load_dwordx4 v7, s[44:47], s5 offen lds
  s_add_u32 m0, s64, 25600
  s_add_u32 s5, s5, 8192
  buffer_load_dwordx4 v7, s[44:47], s5 offen lds
  ds_read_b64_tr_b16 v[168:169], v4 offset:28672
  ds_read_b64_tr_b16 v[170:171], v4 offset:29696
  ds_read_b64_tr_b16 v[172:173], v5 offset:28672
  ds_read_b64_tr_b16 v[174:175], v5 offset:29696
  s_waitcnt lgkmcnt(4)
  s_add_u32 m0, s64, 26624
  s_add_u32 s5, s65, 294912
  buffer_load_dwordx4 v7, s[44:47], s5 offen lds
  s_add_u32 m0, s64, 27648
  s_add_u32 s5, s5, 8192
  buffer_load_dwordx4 v7, s[44:47], s5 offen lds
  s_waitcnt vmcnt(9)
  ds_read_b64_tr_b16 v[176:177], v4 offset:0
  ds_read_b64_tr_b16 v[178:179], v4 offset:1024
  ds_read_b64_tr_b16 v[180:181], v5 offset:0
  ds_read_b64_tr_b16 v[182:183], v5 offset:1024
  s_waitcnt lgkmcnt(4)
  s_add_u32 m0, s64, 28672
  s_add_u32 s5, s65, 311296
  buffer_load_dwordx4 v7, s[44:47], s5 offen lds
  s_add_u32 m0, s64, 29696
  s_add_u32 s5, s5, 8192
  buffer_load_dwordx4 v7, s[44:47], s5 offen lds
  s_waitcnt vmcnt(9)
  ds_read_b64_tr_b16 v[184:185], v4 offset:2048
  ds_read_b64_tr_b16 v[186:187], v4 offset:3072
  ds_read_b64_tr_b16 v[188:189], v5 offset:2048
  ds_read_b64_tr_b16 v[190:191], v5 offset:3072
  s_waitcnt lgkmcnt(4)
  s_add_u32 m0, s64, 0
  s_add_u32 s5, s65, 327680
  buffer_load_dwordx4 v7, s[44:47], s5 offen lds
  s_add_u32 m0, s64, 1024
  s_add_u32 s5, s5, 8192
  buffer_load_dwordx4 v7, s[44:47], s5 offen lds
  s_waitcnt vmcnt(8)
  ds_read_b64_tr_b16 v[192:193], v4 offset:4096
  ds_read_b64_tr_b16 v[194:195], v4 offset:5120
  ds_read_b64_tr_b16 v[196:197], v5 offset:4096
  ds_read_b64_tr_b16 v[198:199], v5 offset:5120
  s_waitcnt lgkmcnt(4)
  s_add_u32 m0, s64, 2048
  s_add_u32 s5, s65, 344064
  buffer_load_dwordx4 v7, s[44:47], s5 offen lds
  s_add_u32 m0, s64, 3072
  s_add_u32 s5, s5, 8192
  buffer_load_dwordx4 v7, s[44:47], s5 offen lds
  s_waitcnt vmcnt(8)
  ds_read_b64_tr_b16 v[200:201], v4 offset:24576
  ds_read_b64_tr_b16 v[202:203], v4 offset:25600
  ds_read_b64_tr_b16 v[204:205], v5 offset:24576
  ds_read_b64_tr_b16 v[206:207], v5 offset:25600
  s_waitcnt lgkmcnt(4)
  s_add_u32 m0, s64, 4096
  s_add_u32 s5, s65, 360448
  buffer_load_dwordx4 v7, s[44:47], s5 offen lds
  s_add_u32 m0, s64, 5120
  s_add_u32 s5, s5, 8192
  buffer_load_dwordx4 v7, s[44:47], s5 offen lds
  s_waitcnt lgkmcnt(0)
  s_load_dwordx8 s[8:15], s[28:29], s90 glc
  s_add_u32 m0, s64, 24576
  s_add_u32 s5, s65, 376832
  buffer_load_dwordx4 v7, s[44:47], s5 offen lds
  s_add_u32 m0, s64, 25600
  s_add_u32 s5, s5, 8192
  buffer_load_dwordx4 v7, s[44:47], s5 offen lds
  s_mov_b32 s52, s22
  s_mov_b32 s53, s23
  s_mov_b32 s54, 1024
  s_mov_b32 s55, 0x20000
  s_mov_b32 s48, s24
  s_mov_b32 s49, s25
  s_mov_b32 s50, 2097152
  s_mov_b32 s51, 0x20000
  s_lshl_b32 s84, s66, 1
  s_add_u32 s84, s84, s67
  s_lshl_b32 s84, s84, 3
  s_add_u32 s84, s84, s56
  s_lshl_b32 s84, s84, 3
  v_lshrrev_b32 v22, 3, v1
  v_add_u32 v22, s84, v22
  v_and_b32 v23, 7, v1
  v_lshlrev_b32 v23, 4, v23
  s_lshl_b32 s85, s68, 7
  v_add_u32 v23, s85, v23
  v_lshl_add_u32 v18, v22, 10, v23
  v_lshlrev_b32 v22, 3, v22
  s_mov_b32 s84, 10485760
  buffer_load_dwordx4 v[24:27], v18, s[32:35], 0 offen
  buffer_load_dwordx4 v[28:31], v23, s[52:55], 0 offen
  buffer_load_dwordx2 v[16:17], v22, s[40:43], s84 offen sc1
  s_mov_b32 s89, 0
  s_add_u32 s85, s59, 1
L_pspin_29:
  s_waitcnt lgkmcnt(0)
  s_sub_u32 s8, s8, s85
  s_sub_u32 s9, s9, s85
  s_sub_u32 s10, s10, s85
  s_sub_u32 s11, s11, s85
  s_sub_u32 s12, s12, s85
  s_sub_u32 s13, s13, s85
  s_sub_u32 s14, s14, s85
  s_sub_u32 s15, s15, s85
  s_max_u32 s8, s8, s9
  s_max_u32 s8, s8, s10
  s_max_u32 s8, s8, s11
  s_max_u32 s8, s8, s12
  s_max_u32 s8, s8, s13
  s_max_u32 s8, s8, s14
  s_max_u32 s8, s8, s15
  s_cmp_lt_u32 s8, 3
  s_cbranch_scc1 L_pok_28
  s_sleep 4
  s_load_dwordx8 s[8:15], s[28:29], s90 glc
  s_add_u32 s89, s89, 1
  s_cmp_lt_u32 s89, 0x40000
  s_cbranch_scc1 L_pspin_29
  s_waitcnt lgkmcnt(0)
L_pok_28:
  s_add_u32 s7, s63, 0
  buffer_load_dwordx4 v[224:227], v15, s[40:43], s7 offen sc1
  buffer_load_dwordx4 v[228:231], v3, s[40:43], s7 offen sc1
  s_add_u32 s7, s63, 1024
  buffer_load_dwordx4 v[232:235], v15, s[40:43], s7 offen sc1
  buffer_load_dwordx4 v[236:239], v3, s[40:43], s7 offen sc1
  s_add_u32 s7, s63, 2048
  buffer_load_dwordx4 v[240:243], v15, s[40:43], s7 offen sc1
  buffer_load_dwordx4 v[244:247], v3, s[40:43], s7 offen sc1
  s_add_u32 s7, s63, 3072
  buffer_load_dwordx4 v[248:251], v15, s[40:43], s7 offen sc1
  buffer_load_dwordx4 v[252:255], v3, s[40:43], s7 offen sc1
  s_add_u32 s7, s63, 4096
  buffer_load_dwordx4 v[32:35], v15, s[40:43], s7 offen sc1
  buffer_load_dwordx4 v[36:39], v3, s[40:43], s7 offen sc1
  s_add_u32 s7, s63, 5120
  buffer_load_dwordx4 v[40:43], v15, s[40:43], s7 offen sc1
  buffer_load_dwordx4 v[44:47], v3, s[40:43], s7 offen sc1
  s_add_u32 s7, s63, 6144
  buffer_load_dwordx4 v[48:51], v15, s[40:43], s7 offen sc1
  buffer_load_dwordx4 v[52:55], v3, s[40:43], s7 offen sc1
  s_waitcnt vmcnt(12)
  v_mfma_f32_32x32x16_bf16 v[64:79], v[128:131], v[224:227], 0
  v_mfma_f32_32x32x16_bf16 v[80:95], v[132:135], v[224:227], 0
  v_mfma_f32_32x32x16_bf16 v[96:111], v[128:131], v[228:231], 0
  v_mfma_f32_32x32x16_bf16 v[112:127], v[132:135], v[228:231], 0
  s_waitcnt vmcnt(10)
  v_mfma_f32_32x32x16_bf16 v[64:79], v[136:139], v[232:235], v[64:79]
  s_add_u32 s7, s63, 7168
  buffer_load_dwordx4 v[224:227], v15, s[40:43], s7 offen sc1
  ds_read_b64_tr_b16 v[208:209], v4 offset:26624
  ds_read_b64_tr_b16 v[210:211], v4 offset:27648
  v_mfma_f32_32x32x16_bf16 v[80:95], v[140:143], v[232:235], v[80:95]
  buffer_load_dwordx4 v[228:231], v3, s[40:43], s7 offen sc1
  ds_read_b64_tr_b16 v[212:213], v5 offset:26624
  ds_read_b64_tr_b16 v[214:215], v5 offset:27648
  v_mfma_f32_32x32x16_bf16 v[96:111], v[136:139], v[236:239], v[96:111]
  v_mfma_f32_32x32x16_bf16 v[112:127], v[140:143], v[236:239], v[112:127]
  s_waitcnt vmcnt(10)
  v_mfma_f32_32x32x16_bf16 v[64:79], v[144:147], v[240:243], v[64:79]
  s_add_u32 s7, s63, 16384
  buffer_load_dwordx4 v[232:235], v15, s[40:43], s7 offen sc1
  ds_read_b64_tr_b16 v[216:217], v4 offset:28672
  ds_read_b64_tr_b16 v[218:219], v4 offset:29696
  v_mfma_f32_32x32x16_bf16 v[80:95], v[148:151], v[240:243], v[80:95]
  buffer_load_dwordx4 v[236:239], v3, s[40:43], s7 offen sc1
  ds_read_b64_tr_b16 v[220:221], v5 offset:28672
  ds_read_b64_tr_b16 v[222:223], v5 offset:29696
  v_mfma_f32_32x32x16_bf16 v[96:111], v[144:147], v[244:247], v[96:111]
  s_waitcnt lgkmcnt(4)
  s_add_u32 m0, s64, 26624
  s_add_u32 s5, s65, 131072
  buffer_load_dwordx4 v7, s[44:47], s5 offen lds
  v_mfma_f32_32x32x16_bf16 v[112:127], v[148:151], v[244:247], v[112:127]
  s_add_u32 m0, s64, 27648
  s_add_u32 s5, s5, 8192
  buffer_load_dwordx4 v7, s[44:47], s5 offen lds
  s_waitcnt vmcnt(12)
  v_mfma_f32_32x32x16_bf16 v[64:79], v[152:155], v[248:251], v[64:79]
  s_add_u32 s7, s63, 17408
  buffer_load_dwordx4 v[240:243], v15, s[40:43], s7 offen sc1
  ds_read_b64_tr_b16 v[128:129], v4 offset:0
  ds_read_b64_tr_b16 v[130:131], v4 offset:1024
  v_mfma_f32_32x32x16_bf16 v[80:95], v[156:159], v[248:251], v[80:95]
  buffer_load_dwordx4 v[244:247], v3, s[40:43], s7 offen sc1
  ds_read_b64_tr_b16 v[132:133], v5 offset:0
  ds_read_b64_tr_b16 v[134:135], v5 offset:1024
  v_mfma_f32_32x32x16_bf16 v[96:111], v[152:155], v[252:255], v[96:111]
  s_waitcnt lgkmcnt(4)
  s_add_u32 m0, s64, 28672
  s_add_u32 s5, s65, 147456
  buffer_load_dwordx4 v7, s[44:47], s5 offen lds
  v_mfma_f32_32x32x16_bf16 v[112:127], v[156:159], v[252:255], v[112:127]
  s_add_u32 m0, s64, 29696
  s_add_u32 s5, s5, 8192
  buffer_load_dwordx4 v7, s[44:47], s5 offen lds
  s_waitcnt vmcnt(14)
  v_mfma_f32_32x32x16_bf16 v[64:79], v[160:163], v[32:35], v[64:79]
  s_add_u32 s7, s63, 18432
  buffer_load_dwordx4 v[248:251], v15, s[40:43], s7 offen sc1
  ds_read_b64_tr_b16 v[136:137], v4 offset:2048
  ds_read_b64_tr_b16 v[138:139], v4 offset:3072
  v_mfma_f32_32x32x16_bf16 v[80:95], v[164:167], v[32:35], v[80:95]
  buffer_load_dwordx4 v[252:255], v3, s[40:43], s7 offen sc1
  ds_read_b64_tr_b16 v[140:141], v5 offset:2048
  ds_read_b64_tr_b16 v[142:143], v5 offset:3072
  v_mfma_f32_32x32x16_bf16 v[96:111], v[160:163], v[36:39], v[96:111]
  s_waitcnt lgkmcnt(4)
  s_add_u32 m0, s64, 0
  s_add_u32 s5, s65, 163840
  buffer_load_dwordx4 v7, s[44:47], s5 offen lds
  v_mfma_f32_32x32x16_bf16 v[112:127], v[164:167], v[36:39], v[112:127]
  s_add_u32 m0, s64, 1024
  s_add_u32 s5, s5, 8192
  buffer_load_dwordx4 v7, s[44:47], s5 offen lds
  s_waitcnt vmcnt(16)
  v_mfma_f32_32x32x16_bf16 v[64:79], v[168:171], v[40:43], v[64:79]
  s_add_u32 s7, s63, 19456
  buffer_load_dwordx4 v[32:35], v15, s[40:43], s7 offen sc1
  ds_read_b64_tr_b16 v[144:145], v4 offset:4096
  ds_read_b64_tr_b16 v[146:147], v4 offset:5120
  v_mfma_f32_32x32x16_bf16 v[80:95], v[172:175], v[40:43], v[80:95]
  buffer_load_dwordx4 v[36:39], v3, s[40:43], s7 offen sc1
  ds_read_b64_tr_b16 v[148:149], v5 offset:4096
  ds_read_b64_tr_b16 v[150:151], v5 offset:5120
  v_mfma_f32_32x32x16_bf16 v[96:111], v[168:171], v[44:47], v[96:111]
  s_waitcnt lgkmcnt(4)
  s_add_u32 m0, s64, 2048
  s_add_u32 s5, s65, 180224
  buffer_load_dwordx4 v7, s[44:47], s5 offen lds
  v_mfma_f32_32x32x16_bf16 v[112:127], v[172:175], v[44:47], v[112:127]
  s_add_u32 m0, s64, 3072
  s_add_u32 s5, s5, 8192
  buffer_load_dwordx4 v7, s[44:47], s5 offen lds
  s_waitcnt vmcnt(18)
  v_mfma_f32_32x32x16_bf16 v[64:79], v[176:179], v[48:51], v[64:79]
  s_add_u32 s7, s63, 20480
  buffer_load_dwordx4 v[40:43], v15, s[40:43], s7 offen sc1
  ds_read_b64_tr_b16 v[152:153], v4 offset:24576
  ds_read_b64_tr_b16 v[154:155], v4 offset:25600
  v_mfma_f32_32x32x16_bf16 v[80:95], v[180:183], v[48:51], v[80:95]
  buffer_load_dwordx4 v[44:47], v3, s[40:43], s7 offen sc1
  ds_read_b64_tr_b16 v[156:157], v5 offset:24576
  ds_read_b64_tr_b16 v[158:159], v5 offset:25600
  v_mfma_f32_32x32x16_bf16 v[96:111], v[176:179], v[52:55], v[96:111]
  s_waitcnt lgkmcnt(4)
  s_add_u32 m0, s64, 4096
  s_add_u32 s5, s65, 393216
  buffer_load_dwordx4 v7, s[44:47], s5 offen lds
  v_mfma_f32_32x32x16_bf16 v[112:127], v[180:183], v[52:55], v[112:127]
  s_add_u32 m0, s64, 5120
  s_add_u32 s5, s5, 8192
  buffer_load_dwordx4 v7, s[44:47], s5 offen lds
  s_load_dwordx8 s[8:15], s[28:29], s90 glc
  s_waitcnt vmcnt(20)
  v_mfma_f32_32x32x16_bf16 v[64:79], v[184:187], v[224:227], v[64:79]
  s_add_u32 s7, s63, 21504
  buffer_load_dwordx4 v[48:51], v15, s[40:43], s7 offen sc1
  s_waitcnt vmcnt(17)
  ds_read_b64_tr_b16 v[160:161], v4 offset:26624
  ds_read_b64_tr_b16 v[162:163], v4 offset:27648
  v_mfma_f32_32x32x16_bf16 v[80:95], v[188:191], v[224:227], v[80:95]
  buffer_load_dwordx4 v[52:55], v3, s[40:43], s7 offen sc1
  ds_read_b64_tr_b16 v[164:165], v5 offset:26624
  ds_read_b64_tr_b16 v[166:167], v5 offset:27648
  v_mfma_f32_32x32x16_bf16 v[96:111], v[184:187], v[228:231], v[96:111]
  s_waitcnt lgkmcnt(4)
  s_add_u32 m0, s64, 24576
  s_add_u32 s5, s65, 409600
  buffer_load_dwordx4 v7, s[44:47], s5 offen lds
  v_mfma_f32_32x32x16_bf16 v[112:127], v[188:191], v[228:231], v[112:127]
  s_add_u32 m0, s64, 25600
  s_add_u32 s5, s5, 8192
  buffer_load_dwordx4 v7, s[44:47], s5 offen lds
  v_mfma_f32_32x32x16_bf16 v[64:79], v[192:195], v[232:235], v[64:79]
  s_add_u32 s7, s63, 22528
  buffer_load_dwordx4 v[224:227], v15, s[40:43], s7 offen sc1
  s_waitcnt vmcnt(17)
  ds_read_b64_tr_b16 v[168:169], v4 offset:28672
  ds_read_b64_tr_b16 v[170:171], v4 offset:29696
  v_mfma_f32_32x32x16_bf16 v[80:95], v[196:199], v[232:235], v[80:95]
  buffer_load_dwordx4 v[228:231], v3, s[40:43], s7 offen sc1
  ds_read_b64_tr_b16 v[172:173], v5 offset:28672
  ds_read_b64_tr_b16 v[174:175], v5 offset:29696
  v_mfma_f32_32x32x16_bf16 v[96:111], v[192:195], v[236:239], v[96:111]
  s_waitcnt lgkmcnt(4)
  s_add_u32 m0, s64, 26624
  s_add_u32 s5, s65, 425984
  buffer_load_dwordx4 v7, s[44:47], s5 offen lds
  v_mfma_f32_32x32x16_bf16 v[112:127], v[196:199], v[236:239], v[112:127]
  s_add_u32 m0, s64, 27648
  s_add_u32 s5, s5, 8192
  buffer_load_dwordx4 v7, s[44:47], s5 offen lds
  v_mfma_f32_32x32x16_bf16 v[64:79], v[200:203], v[240:243], v[64:79]
  s_add_u32 s7, s63, 23552
  buffer_load_dwordx4 v[232:235], v15, s[40:43], s7 offen sc1
  s_waitcnt vmcnt(17)
  ds_read_b64_tr_b16 v[176:177], v4 offset:0
  ds_read_b64_tr_b16 v[178:179], v4 offset:1024
  v_mfma_f32_32x32x16_bf16 v[80:95], v[204:207], v[240:243], v[80:95]
  buffer_load_dwordx4 v[236:239], v3, s[40:43], s7 offen sc1
  ds_read_b64_tr_b16 v[180:181], v5 offset:0
  ds_read_b64_tr_b16 v[182:183], v5 offset:1024
  v_mfma_f32_32x32x16_bf16 v[96:111], v[200:203], v[244:247], v[96:111]
  s_waitcnt lgkmcnt(4)
  s_add_u32 m0, s64, 28672
  s_add_u32 s5, s65, 442368
  buffer_load_dwordx4 v7, s[44:47], s5 offen lds
  v_mfma_f32_32x32x16_bf16 v[112:127], v[204:207], v[244:247], v[112:127]
  s_add_u32 m0, s64, 29696
  s_add_u32 s5, s5, 8192
  buffer_load_dwordx4 v7, s[44:47], s5 offen lds
  s_mov_b32 s89, 0
  s_add_u32 s85, s59, 2
L_pspin_31:
  s_waitcnt lgkmcnt(0)
  s_sub_u32 s8, s8, s85
  s_sub_u32 s10, s10, s85
  s_sub_u32 s12, s12, s85
  s_sub_u32 s14, s14, s85
  s_max_u32 s8, s8, s10
  s_max_u32 s8, s8, s12
  s_max_u32 s8, s8, s14
  s_cmp_lt_u32 s8, 2
  s_cbranch_scc1 L_pok_30
  s_sleep 4
  s_load_dwordx8 s[8:15], s[28:29], s90 glc
  s_add_u32 s89, s89, 1
  s_cmp_lt_u32 s89, 0x40000
  s_cbranch_scc1 L_pspin_31
  s_waitcnt lgkmcnt(0)
L_pok_30:
  v_mfma_f32_32x32x16_bf16 v[64:79], v[208:211], v[248:251], v[64:79]
  s_add_u32 s7, s63, 8192
  buffer_load_dwordx4 v[240:243], v15, s[40:43], s7 offen sc1
  s_waitcnt vmcnt(17)
  ds_read_b64_tr_b16 v[184:185], v4 offset:2048
  ds_read_b64_tr_b16 v[186:187], v4 offset:3072
  v_mfma_f32_32x32x16_bf16 v[80:95], v[212:215], v[248:251], v[80:95]
  buffer_load_dwordx4 v[244:247], v3, s[40:43], s7 offen sc1
  ds_read_b64_tr_b16 v[188:189], v5 offset:2048
  ds_read_b64_tr_b16 v[190:191], v5 offset:3072
  v_mfma_f32_32x32x16_bf16 v[96:111], v[208:211], v[252:255], v[96:111]
  s_add_u32 m0, s64, 0
  s_add_u32 s5, s65, 196608
  buffer_load_dwordx4 v7, s[44:47], s5 offen lds
  v_mfma_f32_32x32x16_bf16 v[112:127], v[212:215], v[252:255], v[112:127]
  s_add_u32 m0, s64, 1024
  s_add_u32 s5, s5, 8192
  buffer_load_dwordx4 v7, s[44:47], s5 offen lds
  v_mfma_f32_32x32x16_bf16 v[64:79], v[216:219], v[32:35], v[64:79]
  s_add_u32 s7, s63, 9216
  buffer_load_dwordx4 v[248:251], v15, s[40:43], s7 offen sc1
  s_waitcnt vmcnt(17)
  ds_read_b64_tr_b16 v[192:193], v4 offset:4096
  ds_read_b64_tr_b16 v[194:195], v4 offset:5120
  v_mfma_f32_32x32x16_bf16 v[80:95], v[220:223], v[32:35], v[80:95]
  buffer_load_dwordx4 v[252:255], v3, s[40:43], s7 offen sc1
  ds_read_b64_tr_b16 v[196:197], v5 offset:4096
  ds_read_b64_tr_b16 v[198:199], v5 offset:5120
  v_mfma_f32_32x32x16_bf16 v[96:111], v[216:219], v[36:39], v[96:111]
  s_waitcnt lgkmcnt(4)
  s_add_u32 m0, s64, 2048
  s_add_u32 s5, s65, 212992
  buffer_load_dwordx4 v7, s[44:47], s5 offen lds
  v_mfma_f32_32x32x16_bf16 v[112:127], v[220:223], v[36:39], v[112:127]
  s_add_u32 m0, s64, 3072
  s_add_u32 s5, s5, 8192
  buffer_load_dwordx4 v7, s[44:47], s5 offen lds
  v_mfma_f32_32x32x16_bf16 v[64:79], v[128:131], v[40:43], v[64:79]
  s_add_u32 s7, s63, 10240
  buffer_load_dwordx4 v[32:35], v15, s[40:43], s7 offen sc1
  s_waitcnt vmcnt(17)
  ds_read_b64_tr_b16 v[200:201], v4 offset:24576
  ds_read_b64_tr_b16 v[202:203], v4 offset:25600
  v_mfma_f32_32x32x16_bf16 v[80:95], v[132:135], v[40:43], v[80:95]
  buffer_load_dwordx4 v[36:39], v3, s[40:43], s7 offen sc1
  ds_read_b64_tr_b16 v[204:205], v5 offset:24576
  ds_read_b64_tr_b16 v[206:207], v5 offset:25600
  v_mfma_f32_32x32x16_bf16 v[96:111], v[128:131], v[44:47], v[96:111]
  s_waitcnt lgkmcnt(4)
  s_add_u32 m0, s64, 4096
  s_add_u32 s5, s65, 229376
  buffer_load_dwordx4 v7, s[44:47], s5 offen lds
  v_mfma_f32_32x32x16_bf16 v[112:127], v[132:135], v[44:47], v[112:127]
  s_add_u32 m0, s64, 5120
  s_add_u32 s5, s5, 8192
  buffer_load_dwordx4 v7, s[44:47], s5 offen lds
  v_add_u32 v22, s64, v15
  v_add_u32 v23, -41984, v22
  v_and_b32 v56, 7, v1
  v_lshrrev_b32 v57, 3, v1
  s_lshl_b32 s86, s60, 3
  v_add_u32 v57, s86, v57
  v_mfma_f32_32x32x16_bf16 v[64:79], v[136:139], v[48:51], v[64:79]
  s_add_u32 s7, s63, 11264
  buffer_load_dwordx4 v[40:43], v15, s[40:43], s7 offen sc1
  s_waitcnt vmcnt(17)
  ds_read_b64_tr_b16 v[208:209], v4 offset:26624
  ds_read_b64_tr_b16 v[210:211], v4 offset:27648
  v_mfma_f32_32x32x16_bf16 v[80:95], v[140:143], v[48:51], v[80:95]
  buffer_load_dwordx4 v[44:47], v3, s[40:43], s7 offen sc1
  ds_read_b64_tr_b16 v[212:213], v5 offset:26624
  ds_read_b64_tr_b16 v[214:215], v5 offset:27648
  v_mfma_f32_32x32x16_bf16 v[96:111], v[136:139], v[52:55], v[96:111]
  s_waitcnt lgkmcnt(4)
  s_add_u32 m0, s64, 24576
  s_add_u32 s5, s65, 245760
  buffer_load_dwordx4 v7, s[44:47], s5 offen lds
  v_mfma_f32_32x32x16_bf16 v[112:127], v[140:143], v[52:55], v[112:127]
  s_add_u32 m0, s64, 25600
  s_add_u32 s5, s5, 8192
  buffer_load_dwordx4 v7, s[44:47], s5 offen lds
  v_lshlrev_b32 v2, 1, v56
  v_xor_b32 v57, v57, v2
  v_lshlrev_b32 v57, 4, v57
  s_lshl_b32 s86, s61, 3
  v_add_u32 v56, s86, v56
  v_lshl_add_u32 v2, v56, 10, v57
  v_mfma_f32_32x32x16_bf16 v[64:79], v[144:147], v[224:227], v[64:79]
  s_add_u32 s7, s63, 24576
  buffer_load_dwordx4 v[48:51], v15, s[40:43], s7 offen sc1
  s_waitcnt vmcnt(17)
  ds_read_b64_tr_b16 v[216:217], v4 offset:28672
  ds_read_b64_tr_b16 v[218:219], v4 offset:29696
  v_mfma_f32_32x32x16_bf16 v[80:95], v[148:151], v[224:227], v[80:95]
  buffer_load_dwordx4 v[52:55], v3, s[40:43], s7 offen sc1
  ds_read_b64_tr_b16 v[220:221], v5 offset:28672
  ds_read_b64_tr_b16 v[222:223], v5 offset:29696
  v_mfma_f32_32x32x16_bf16 v[96:111], v[144:147], v[228:231], v[96:111]
  v_mfma_f32_32x32x16_bf16 v[112:127], v[148:151], v[228:231], v[112:127]
  s_load_dwordx8 s[8:15], s[28:29], s90 glc
  v_add_u32 v6, 107520, v2
  v_add_u32 v57, 125952, v2
  v_cmp_le_u32 vcc, 6, v56
  v_add_u32 v58, 53248, v2
  v_cmp_le_u32 s[86:87], 12, v56
  v_cndmask_b32 v6, v6, v57, vcc
  v_mfma_f32_32x32x16_bf16 v[64:79], v[152:155], v[232:235], v[64:79]
  s_add_u32 s7, s63, 25600
  buffer_load_dwordx4 v[224:227], v15, s[40:43], s7 offen sc1
  s_waitcnt vmcnt(15)
  ds_read_b64_tr_b16 v[128:129], v4 offset:0
  ds_read_b64_tr_b16 v[130:131], v4 offset:1024
  v_mfma_f32_32x32x16_bf16 v[80:95], v[156:159], v[232:235], v[80:95]
  buffer_load_dwordx4 v[228:231], v3, s[40:43], s7 offen sc1
  ds_read_b64_tr_b16 v[132:133], v5 offset:0
  ds_read_b64_tr_b16 v[134:135], v5 offset:1024
  v_mfma_f32_32x32x16_bf16 v[96:111], v[152:155], v[236:239], v[96:111]
  v_mfma_f32_32x32x16_bf16 v[112:127], v[156:159], v[236:239], v[112:127]
  v_and_b32 v16, 0xffff0000, v16
  v_cndmask_b32 v6, v6, v58, s[86:87]
  s_mul_i32 s86, s61, 24576
  v_add_u32 v2, s86, v2
  v_rcp_f32 v16, v16
  v_lshlrev_b32 v56, 16, v28
  v_mfma_f32_32x32x16_bf16 v[64:79], v[160:163], v[240:243], v[64:79]
  s_add_u32 s7, s63, 26624
  buffer_load_dwordx4 v[232:235], v15, s[40:43], s7 offen sc1
  s_waitcnt vmcnt(13)
  ds_read_b64_tr_b16 v[136:137], v4 offset:2048
  ds_read_b64_tr_b16 v[138:139], v4 offset:3072
  v_mfma_f32_32x32x16_bf16 v[80:95], v[164:167], v[240:243], v[80:95]
  buffer_load_dwordx4 v[236:239], v3, s[40:43], s7 offen sc1
  ds_read_b64_tr_b16 v[140:141], v5 offset:2048
  ds_read_b64_tr_b16 v[142:143], v5 offset:3072
  v_mfma_f32_32x32x16_bf16 v[96:111], v[160:163], v[244:247], v[96:111]
  v_mfma_f32_32x32x16_bf16 v[112:127], v[164:167], v[244:247], v[112:127]
  v_and_b32 v57, 0xffff0000, v28
  v_mul_f32 v16, v16, v16
  v_lshlrev_b32 v58, 16, v29
  v_and_b32 v59, 0xffff0000, v29
  v_lshlrev_b32 v60, 16, v30
  v_and_b32 v61, 0xffff0000, v30
  v_mfma_f32_32x32x16_bf16 v[64:79], v[168:171], v[248:251], v[64:79]
  s_add_u32 s7, s63, 27648
  buffer_load_dwordx4 v[240:243], v15, s[40:43], s7 offen sc1
  s_waitcnt vmcnt(11)
  ds_read_b64_tr_b16 v[144:145], v4 offset:4096
  ds_read_b64_tr_b16 v[146:147], v4 offset:5120
  v_mfma_f32_32x32x16_bf16 v[80:95], v[172:175], v[248:251], v[80:95]
  buffer_load_dwordx4 v[244:247], v3, s[40:43], s7 offen sc1
  ds_read_b64_tr_b16 v[148:149], v5 offset:4096
  ds_read_b64_tr_b16 v[150:151], v5 offset:5120
  v_mfma_f32_32x32x16_bf16 v[96:111], v[168:171], v[252:255], v[96:111]
  v_mfma_f32_32x32x16_bf16 v[112:127], v[172:175], v[252:255], v[112:127]
  v_lshlrev_b32 v28, 16, v31
  v_and_b32 v29, 0xffff0000, v31
  v_lshlrev_b32 v12, 16, v24
  v_lshlrev_b32 v13, 16, v25
  v_lshlrev_b32 v14, 16, v26
  v_lshlrev_b32 v19, 16, v27
  s_mov_b32 s89, 0
  s_add_u32 s85, s59, 3
L_pspin_33:
  s_waitcnt lgkmcnt(0)
  s_sub_u32 s8, s8, s85
  s_sub_u32 s10, s10, s85
  s_sub_u32 s12, s12, s85
  s_sub_u32 s14, s14, s85
  s_max_u32 s8, s8, s10
  s_max_u32 s8, s8, s12
  s_max_u32 s8, s8, s14
  s_cmp_lt_u32 s8, 1
  s_cbranch_scc1 L_pok_32
  s_sleep 4
  s_load_dwordx8 s[8:15], s[28:29], s90 glc
  s_add_u32 s89, s89, 1
  s_cmp_lt_u32 s89, 0x40000
  s_cbranch_scc1 L_pspin_33
  s_waitcnt lgkmcnt(0)
L_pok_32:
  v_mfma_f32_32x32x16_bf16 v[64:79], v[176:179], v[32:35], v[64:79]
  s_add_u32 s7, s63, 12288
  buffer_load_dwordx4 v[248:251], v15, s[40:43], s7 offen sc1
  s_waitcnt vmcnt(9)
  ds_read_b64_tr_b16 v[152:153], v4 offset:24576
  ds_read_b64_tr_b16 v[154:155], v4 offset:25600
  v_mfma_f32_32x32x16_bf16 v[80:95], v[180:183], v[32:35], v[80:95]
  buffer_load_dwordx4 v[252:255], v3, s[40:43], s7 offen sc1
  ds_read_b64_tr_b16 v[156:157], v5 offset:24576
  ds_read_b64_tr_b16 v[158:159], v5 offset:25600
  v_mfma_f32_32x32x16_bf16 v[96:111], v[176:179], v[36:39], v[96:111]
  v_mfma_f32_32x32x16_bf16 v[112:127], v[180:183], v[36:39], v[112:127]
  v_and_b32 v24, 0xffff0000, v24
  v_and_b32 v25, 0xffff0000, v25
  v_and_b32 v26, 0xffff0000, v26
  v_and_b32 v27, 0xffff0000, v27
  v_mfma_f32_32x32x16_bf16 v[64:79], v[184:187], v[40:43], v[64:79]
  s_add_u32 s7, s63, 13312
  buffer_load_dwordx4 v[32:35], v15, s[40:43], s7 offen sc1
  v_mfma_f32_32x32x16_bf16 v[80:95], v[188:191], v[40:43], v[80:95]
  buffer_load_dwordx4 v[36:39], v3, s[40:43], s7 offen sc1
  v_mfma_f32_32x32x16_bf16 v[96:111], v[184:187], v[44:47], v[96:111]
  v_mfma_f32_32x32x16_bf16 v[112:127], v[188:191], v[44:47], v[112:127]
  s_waitcnt vmcnt(10)
  v_mfma_f32_32x32x16_bf16 v[64:79], v[192:195], v[48:51], v[64:79]
  s_add_u32 s7, s63, 14336
  buffer_load_dwordx4 v[40:43], v15, s[40:43], s7 offen sc1
  v_mfma_f32_32x32x16_bf16 v[80:95], v[196:199], v[48:51], v[80:95]
  buffer_load_dwordx4 v[44:47], v3, s[40:43], s7 offen sc1
  v_mfma_f32_32x32x16_bf16 v[96:111], v[192:195], v[52:55], v[96:111]
  v_mfma_f32_32x32x16_bf16 v[112:127], v[196:199], v[52:55], v[112:127]
  s_waitcnt vmcnt(10)
  v_mfma_f32_32x32x16_bf16 v[64:79], v[200:203], v[224:227], v[64:79]
  s_add_u32 s7, s63, 15360
  buffer_load_dwordx4 v[48:51], v15, s[40:43], s7 offen sc1
  v_mfma_f32_32x32x16_bf16 v[80:95], v[204:207], v[224:227], v[80:95]
  buffer_load_dwordx4 v[52:55], v3, s[40:43], s7 offen sc1
  v_mfma_f32_32x32x16_bf16 v[96:111], v[200:203], v[228:231], v[96:111]
  v_mfma_f32_32x32x16_bf16 v[112:127], v[204:207], v[228:231], v[112:127]
  s_waitcnt vmcnt(10)
  v_mfma_f32_32x32x16_bf16 v[64:79], v[208:211], v[232:235], v[64:79]
  v_mfma_f32_32x32x16_bf16 v[80:95], v[212:215], v[232:235], v[80:95]
  v_mfma_f32_32x32x16_bf16 v[96:111], v[208:211], v[236:239], v[96:111]
  v_mfma_f32_32x32x16_bf16 v[112:127], v[212:215], v[236:239], v[112:127]
  s_waitcnt vmcnt(0) lgkmcnt(0)
  s_setprio 1
  v_mov_b32 v21, 162304
  ds_read_b32 v62, v21
  v_mfma_f32_32x32x16_bf16 v[64:79], v[216:219], v[240:243], v[64:79]
  v_mfma_f32_32x32x16_bf16 v[64:79], v[128:131], v[248:251], v[64:79]
  v_mfma_f32_32x32x16_bf16 v[64:79], v[136:139], v[32:35], v[64:79]
  v_mfma_f32_32x32x16_bf16 v[64:79], v[144:147], v[40:43], v[64:79]
  v_mfma_f32_32x32x16_bf16 v[64:79], v[152:155], v[48:51], v[64:79]
  v_mfma_f32_32x32x16_bf16 v[80:95], v[220:223], v[240:243], v[80:95]
  v_mfma_f32_32x32x16_bf16 v[80:95], v[132:135], v[248:251], v[80:95]
  v_xor_b32 v8, 0, v22
  s_nop 8
  ds_write_b128 v8, v[64:67] offset:0
  v_mfma_f32_32x32x16_bf16 v[80:95], v[140:143], v[32:35], v[80:95]
  v_xor_b32 v9, 32, v22
  ds_write_b128 v9, v[68:71] offset:1024
  v_mfma_f32_32x32x16_bf16 v[80:95], v[148:151], v[40:43], v[80:95]
  v_xor_b32 v10, 64, v22
  ds_write_b128 v10, v[72:75] offset:2048
  v_mfma_f32_32x32x16_bf16 v[80:95], v[156:159], v[48:51], v[80:95]
  v_xor_b32 v11, 96, v22
  ds_write_b128 v11, v[76:79] offset:3072
  v_mfma_f32_32x32x16_bf16 v[96:111], v[216:219], v[244:247], v[96:111]
  v_mfma_f32_32x32x16_bf16 v[96:111], v[128:131], v[252:255], v[96:111]
  v_xor_b32 v8, 128, v22
  s_nop 6
  ds_write_b128 v8, v[80:83] offset:4096
  v_mfma_f32_32x32x16_bf16 v[96:111], v[136:139], v[36:39], v[96:111]
  v_xor_b32 v9, 160, v22
  ds_write_b128 v9, v[84:87] offset:5120
  v_mfma_f32_32x32x16_bf16 v[96:111], v[144:147], v[44:47], v[96:111]
  v_xor_b32 v10, 192, v22
  ds_write_b128 v10, v[88:91] offset:24576
  v_mfma_f32_32x32x16_bf16 v[96:111], v[152:155], v[52:55], v[96:111]
  v_xor_b32 v11, 224, v22
  ds_write_b128 v11, v[92:95] offset:25600
  v_mfma_f32_32x32x16_bf16 v[112:127], v[220:223], v[244:247], v[112:127]
  v_mfma_f32_32x32x16_bf16 v[112:127], v[132:135], v[252:255], v[112:127]
  v_xor_b32 v8, 0, v22
  s_nop 6
  ds_write_b128 v8, v[96:99] offset:26624
  v_mfma_f32_32x32x16_bf16 v[112:127], v[140:143], v[36:39], v[112:127]
  v_xor_b32 v9, 32, v22
  ds_write_b128 v9, v[100:103] offset:27648
  v_mfma_f32_32x32x16_bf16 v[112:127], v[148:151], v[44:47], v[112:127]
  v_xor_b32 v10, 64, v22
  ds_write_b128 v10, v[104:107] offset:28672
  v_mfma_f32_32x32x16_bf16 v[112:127], v[156:159], v[52:55], v[112:127]
  v_xor_b32 v11, 96, v22
  ds_write_b128 v11, v[108:111] offset:29696
  s_waitcnt lgkmcnt(12)
  v_readfirstlane_b32 s84, v62
  s_nop 0
  s_bfe_u32 s84, s84, 262148
  s_cmp_eq_u32 s84, 4
  s_cbranch_scc1 L_cok_34
L_cspin_35:
  ds_read_b32 v62, v21
  s_waitcnt lgkmcnt(0)
  v_readfirstlane_b32 s84, v62
  s_nop 0
  s_bfe_u32 s84, s84, 262148
  s_cmp_lg_u32 s84, 4
  s_cbranch_scc1 L_cspin_35
L_cok_34:
  v_xor_b32 v8, 128, v23
  s_nop 2
  ds_write_b128 v8, v[112:115] offset:0
  v_xor_b32 v9, 160, v23
  ds_write_b128 v9, v[116:119] offset:1024
  v_xor_b32 v10, 192, v23
  ds_write_b128 v10, v[120:123] offset:2048
  v_xor_b32 v11, 224, v23
  ds_write_b128 v11, v[124:127] offset:3072
  s_branch L_final
L_p3s:
  s_nop 1
  s_mov_b32 s52, s22
  s_mov_b32 s53, s23
  s_mov_b32 s54, 1024
  s_mov_b32 s55, 0x20000
  s_mov_b32 s48, s24
  s_mov_b32 s49, s25
  s_mov_b32 s50, 2097152
  s_mov_b32 s51, 0x20000
  s_lshl_b32 s84, s66, 1
  s_add_u32 s84, s84, s67
  s_lshl_b32 s84, s84, 3
  s_add_u32 s84, s84, s56
  s_lshl_b32 s84, s84, 3
  v_lshrrev_b32 v22, 3, v1
  v_add_u32 v22, s84, v22
  v_and_b32 v23, 7, v1
  v_lshlrev_b32 v23, 4, v23
  s_lshl_b32 s85, s68, 7
  v_add_u32 v23, s85, v23
  v_lshl_add_u32 v18, v22, 10, v23
  v_lshlrev_b32 v22, 3, v22
  s_mov_b32 s84, 10485760
  buffer_load_dwordx4 v[24:27], v18, s[32:35], 0 offen
  buffer_load_dwordx4 v[28:31], v23, s[52:55], 0 offen
  buffer_load_dwordx2 v[16:17], v22, s[40:43], s84 offen sc1
  s_waitcnt vmcnt(3)
  ds_read_b64_tr_b16 v[128:129], v4 offset:0
  ds_read_b64_tr_b16 v[130:131], v4 offset:1024
  ds_read_b64_tr_b16 v[132:133], v5 offset:0
  ds_read_b64_tr_b16 v[134:135], v5 offset:1024
  ds_read_b64_tr_b16 v[136:137], v4 offset:512
  ds_read_b64_tr_b16 v[138:139], v4 offset:1536
  ds_read_b64_tr_b16 v[140:141], v5 offset:512
  ds_read_b64_tr_b16 v[142:143], v5 offset:1536
  s_waitcnt lgkmcnt(4)
  ds_read_b64_tr_b16 v[144:145], v4 offset:4096
  ds_read_b64_tr_b16 v[146:147], v4 offset:5120
  ds_read_b64_tr_b16 v[148:149], v5 offset:4096
  ds_read_b64_tr_b16 v[150:151], v5 offset:5120
  ds_read_b64_tr_b16 v[152:153], v4 offset:4608
  ds_read_b64_tr_b16 v[154:155], v4 offset:5632
  ds_read_b64_tr_b16 v[156:157], v5 offset:4608
  ds_read_b64_tr_b16 v[158:159], v5 offset:5632
  s_waitcnt lgkmcnt(4)
  ds_read_b64_tr_b16 v[160:161], v4 offset:32768
  ds_read_b64_tr_b16 v[162:163], v4 offset:33792
  ds_read_b64_tr_b16 v[164:165], v5 offset:32768
  ds_read_b64_tr_b16 v[166:167], v5 offset:33792
  ds_read_b64_tr_b16 v[168:169], v4 offset:33280
  ds_read_b64_tr_b16 v[170:171], v4 offset:34304
  ds_read_b64_tr_b16 v[172:173], v5 offset:33280
  ds_read_b64_tr_b16 v[174:175], v5 offset:34304
  s_waitcnt lgkmcnt(4)
  ds_read_b64_tr_b16 v[176:177], v4 offset:36864
  ds_read_b64_tr_b16 v[178:179], v4 offset:37888
  ds_read_b64_tr_b16 v[180:181], v5 offset:36864
  ds_read_b64_tr_b16 v[182:183], v5 offset:37888
  ds_read_b64_tr_b16 v[184:185], v4 offset:37376
  ds_read_b64_tr_b16 v[186:187], v4 offset:38400
  ds_read_b64_tr_b16 v[188:189], v5 offset:37376
  ds_read_b64_tr_b16 v[190:191], v5 offset:38400
  s_waitcnt lgkmcnt(4)
  s_or_b32 s84, s2, s56
  s_cbranch_scc1 L_eskip_36
  v_lshlrev_b32 v8, 6, v1
  s_mov_b32 s86, 10485764
  s_mov_b32 s89, 0
L_espin_37:
  buffer_load_dword v9, v8, s[40:43], s86 offen sc1
  v_add_u32 v13, 4096, v8
  buffer_load_dword v10, v13, s[40:43], s86 offen sc1
  v_add_u32 v13, 8192, v8
  buffer_load_dword v11, v13, s[40:43], s86 offen sc1
  v_add_u32 v13, 12288, v8
  buffer_load_dword v12, v13, s[40:43], s86 offen sc1
  s_waitcnt vmcnt(0)
  v_xor_b32 v9, s59, v9
  v_xor_b32 v10, s59, v10
  v_xor_b32 v11, s59, v11
  v_xor_b32 v12, s59, v12
  v_or3_b32 v9, v9, v10, v11
  v_or_b32 v9, v9, v12
  v_cmp_ne_u32 vcc, 0, v9
  s_cbranch_vccz L_ego_38
  s_sleep 8
  s_add_u32 s89, s89, 1
  s_cmp_lt_u32 s89, 0x8000
  s_cbranch_scc1 L_espin_37
L_ego_38:
  s_add_u32 s84, s73, 1
  s_mov_b32 s86, 10731520
  v_mov_b32 v62, s84
  s_mov_b64 exec, 1
  buffer_store_dword v62, off, s[40:43], s86 sc1
  s_mov_b64 exec, -1
L_eskip_36:
  s_waitcnt vmcnt(0)
  v_add_u32 v22, s64, v15
  v_add_u32 v23, -41984, v22
  v_and_b32 v56, 7, v1
  v_lshrrev_b32 v57, 3, v1
  s_lshl_b32 s86, s60, 3
  v_add_u32 v57, s86, v57
  v_lshlrev_b32 v2, 1, v56
  v_xor_b32 v57, v57, v2
  v_lshlrev_b32 v57, 4, v57
  s_lshl_b32 s86, s61, 3
  v_add_u32 v56, s86, v56
  v_lshl_add_u32 v2, v56, 10, v57
  v_add_u32 v6, 107520, v2
  v_add_u32 v57, 125952, v2
  v_cmp_le_u32 vcc, 6, v56
  v_add_u32 v58, 53248, v2
  v_cmp_le_u32 s[86:87], 12, v56
  v_cndmask_b32 v6, v6, v57, vcc
  v_and_b32 v16, 0xffff0000, v16
  v_cndmask_b32 v6, v6, v58, s[86:87]
  s_mul_i32 s86, s61, 24576
  v_add_u32 v2, s86, v2
  v_rcp_f32 v16, v16
  v_lshlrev_b32 v56, 16, v28
  v_and_b32 v57, 0xffff0000, v28
  v_mul_f32 v16, v16, v16
  v_lshlrev_b32 v58, 16, v29
  v_and_b32 v59, 0xffff0000, v29
  v_lshlrev_b32 v60, 16, v30
  v_and_b32 v61, 0xffff0000, v30
  v_lshlrev_b32 v28, 16, v31
  v_and_b32 v29, 0xffff0000, v31
  v_lshlrev_b32 v12, 16, v24
  v_lshlrev_b32 v13, 16, v25
  v_lshlrev_b32 v14, 16, v26
  v_lshlrev_b32 v19, 16, v27
  v_and_b32 v24, 0xffff0000, v24
  v_and_b32 v25, 0xffff0000, v25
  v_and_b32 v26, 0xffff0000, v26
  v_and_b32 v27, 0xffff0000, v27
  s_load_dwordx8 s[8:15], s[28:29], s90 glc
  s_mov_b32 s89, 0
  s_add_u32 s85, s59, 3
L_pspin_40:
  s_waitcnt lgkmcnt(0)
  s_sub_u32 s8, s8, s85
  s_sub_u32 s10, s10, s85
  s_sub_u32 s12, s12, s85
  s_sub_u32 s14, s14, s85
  s_max_u32 s8, s8, s10
  s_max_u32 s8, s8, s12
  s_max_u32 s8, s8, s14
  s_cmp_lt_u32 s8, 1
  s_cbranch_scc1 L_pok_39
  s_sleep 16
  s_load_dwordx8 s[8:15], s[28:29], s90 glc
  s_add_u32 s89, s89, 1
  s_cmp_lt_u32 s89, 0x40000
  s_cbranch_scc1 L_pspin_40
  s_waitcnt lgkmcnt(0)
L_pok_39:
  s_add_u32 s84, s63, 0
  buffer_load_dwordx4 v[192:195], v15, s[40:43], s84 offen sc1
  buffer_load_dwordx4 v[196:199], v3, s[40:43], s84 offen sc1
  s_add_u32 s84, s63, 1024
  buffer_load_dwordx4 v[200:203], v15, s[40:43], s84 offen sc1
  buffer_load_dwordx4 v[204:207], v3, s[40:43], s84 offen sc1
  s_add_u32 s84, s63, 2048
  buffer_load_dwordx4 v[208:211], v15, s[40:43], s84 offen sc1
  buffer_load_dwordx4 v[212:215], v3, s[40:43], s84 offen sc1
  s_add_u32 s84, s63, 3072
  buffer_load_dwordx4 v[216:219], v15, s[40:43], s84 offen sc1
  buffer_load_dwordx4 v[220:223], v3, s[40:43], s84 offen sc1
  s_add_u32 s84, s63, 4096
  buffer_load_dwordx4 v[224:227], v15, s[40:43], s84 offen sc1
  buffer_load_dwordx4 v[228:231], v3, s[40:43], s84 offen sc1
  s_add_u32 s84, s63, 5120
  buffer_load_dwordx4 v[232:235], v15, s[40:43], s84 offen sc1
  buffer_load_dwordx4 v[236:239], v3, s[40:43], s84 offen sc1
  s_add_u32 s84, s63, 6144
  buffer_load_dwordx4 v[240:243], v15, s[40:43], s84 offen sc1
  buffer_load_dwordx4 v[244:247], v3, s[40:43], s84 offen sc1
  s_add_u32 s84, s63, 7168
  buffer_load_dwordx4 v[248:251], v15, s[40:43], s84 offen sc1
  buffer_load_dwordx4 v[252:255], v3, s[40:43], s84 offen sc1
  s_waitcnt lgkmcnt(0)
  s_waitcnt vmcnt(14)
  v_mfma_f32_32x32x16_bf16 v[64:79], v[128:131], v[192:195], 0
  v_mfma_f32_32x32x16_bf16 v[80:95], v[132:135], v[192:195], 0
  v_mfma_f32_32x32x16_bf16 v[96:111], v[128:131], v[196:199], 0
  v_mfma_f32_32x32x16_bf16 v[112:127], v[132:135], v[196:199], 0
  s_waitcnt vmcnt(12)
  v_mfma_f32_32x32x16_bf16 v[64:79], v[136:139], v[200:203], v[64:79]
  v_mfma_f32_32x32x16_bf16 v[80:95], v[140:143], v[200:203], v[80:95]
  v_mfma_f32_32x32x16_bf16 v[96:111], v[136:139], v[204:207], v[96:111]
  v_mfma_f32_32x32x16_bf16 v[112:127], v[140:143], v[204:207], v[112:127]
  s_waitcnt vmcnt(10)
  v_mfma_f32_32x32x16_bf16 v[64:79], v[144:147], v[208:211], v[64:79]
  v_mfma_f32_32x32x16_bf16 v[80:95], v[148:151], v[208:211], v[80:95]
  v_mfma_f32_32x32x16_bf16 v[96:111], v[144:147], v[212:215], v[96:111]
  v_mfma_f32_32x32x16_bf16 v[112:127], v[148:151], v[212:215], v[112:127]
  s_waitcnt vmcnt(8)
  v_mfma_f32_32x32x16_bf16 v[64:79], v[152:155], v[216:219], v[64:79]
  v_mfma_f32_32x32x16_bf16 v[80:95], v[156:159], v[216:219], v[80:95]
  v_mfma_f32_32x32x16_bf16 v[96:111], v[152:155], v[220:223], v[96:111]
  v_mfma_f32_32x32x16_bf16 v[112:127], v[156:159], v[220:223], v[112:127]
  s_waitcnt vmcnt(0)
  v_mfma_f32_32x32x16_bf16 v[64:79], v[160:163], v[224:227], v[64:79]
  v_mfma_f32_32x32x16_bf16 v[64:79], v[168:171], v[232:235], v[64:79]
  v_mfma_f32_32x32x16_bf16 v[64:79], v[176:179], v[240:243], v[64:79]
  v_mfma_f32_32x32x16_bf16 v[64:79], v[184:187], v[248:251], v[64:79]
  v_mfma_f32_32x32x16_bf16 v[80:95], v[164:167], v[224:227], v[80:95]
  v_mfma_f32_32x32x16_bf16 v[80:95], v[172:175], v[232:235], v[80:95]
  v_xor_b32 v8, 0, v22
  s_nop 8
  ds_write_b128 v8, v[64:67] offset:0
  v_mfma_f32_32x32x16_bf16 v[80:95], v[180:183], v[240:243], v[80:95]
  v_xor_b32 v9, 32, v22
  ds_write_b128 v9, v[68:71] offset:1024
  v_mfma_f32_32x32x16_bf16 v[80:95], v[188:191], v[248:251], v[80:95]
  v_xor_b32 v10, 64, v22
  ds_write_b128 v10, v[72:75] offset:2048
  v_xor_b32 v11, 96, v22
  ds_write_b128 v11, v[76:79] offset:3072
  v_mfma_f32_32x32x16_bf16 v[96:111], v[160:163], v[228:231], v[96:111]
  v_mfma_f32_32x32x16_bf16 v[96:111], v[168:171], v[236:239], v[96:111]
  v_xor_b32 v8, 128, v22
  s_nop 4
  ds_write_b128 v8, v[80:83] offset:4096
  v_mfma_f32_32x32x16_bf16 v[96:111], v[176:179], v[244:247], v[96:111]
  v_xor_b32 v9, 160, v22
  ds_write_b128 v9, v[84:87] offset:5120
  v_mfma_f32_32x32x16_bf16 v[96:111], v[184:187], v[252:255], v[96:111]
  v_xor_b32 v10, 192, v22
  ds_write_b128 v10, v[88:91] offset:6144
  v_xor_b32 v11, 224, v22
  ds_write_b128 v11, v[92:95] offset:7168
  v_mfma_f32_32x32x16_bf16 v[112:127], v[164:167], v[228:231], v[112:127]
  v_mfma_f32_32x32x16_bf16 v[112:127], v[172:175], v[236:239], v[112:127]
  v_xor_b32 v8, 0, v22
  s_nop 4
  ds_write_b128 v8, v[96:99] offset:32768
  v_mfma_f32_32x32x16_bf16 v[112:127], v[180:183], v[244:247], v[112:127]
  v_xor_b32 v9, 32, v22
  ds_write_b128 v9, v[100:103] offset:33792
  v_mfma_f32_32x32x16_bf16 v[112:127], v[188:191], v[252:255], v[112:127]
  v_xor_b32 v10, 64, v22
  ds_write_b128 v10, v[104:107] offset:34816
  v_xor_b32 v11, 96, v22
  ds_write_b128 v11, v[108:111] offset:35840
  v_xor_b32 v8, 128, v22
  s_nop 6
  ds_write_b128 v8, v[112:115] offset:36864
  v_xor_b32 v9, 160, v22
  ds_write_b128 v9, v[116:119] offset:37888
  v_xor_b32 v10, 192, v22
  ds_write_b128 v10, v[120:123] offset:38912
  v_xor_b32 v11, 224, v22
  ds_write_b128 v11, v[124:127] offset:39936
L_final:
  s_waitcnt lgkmcnt(0)
  s_barrier
  ds_read_b128 v[128:131], v6 offset:0
  ds_read_b128 v[132:135], v6 offset:512
  ds_read_b128 v[136:139], v6 offset:6144
  ds_read_b128 v[140:143], v6 offset:6656
  ds_read_b128 v[144:147], v6 offset:12288
  ds_read_b128 v[148:151], v6 offset:12800
  ds_read_b128 v[152:155], v6 offset:18432
  ds_read_b128 v[156:159], v6 offset:18944
  ds_read_b128 v[160:163], v2 offset:0
  ds_read_b128 v[164:167], v2 offset:512
  ds_read_b128 v[168:171], v2 offset:8192
  ds_read_b128 v[172:175], v2 offset:8704
  ds_read_b128 v[176:179], v2 offset:16384
  ds_read_b128 v[180:183], v2 offset:16896
  ds_read_b128 v[184:187], v2 offset:24576
  ds_read_b128 v[188:191], v2 offset:25088
  s_waitcnt lgkmcnt(12)
  v_add_f32 v128, v128, v136
  v_add_f32 v129, v129, v137
  v_add_f32 v130, v130, v138
  v_add_f32 v131, v131, v139
  v_add_f32 v132, v132, v140
  v_add_f32 v133, v133, v141
  v_add_f32 v134, v134, v142
  v_add_f32 v135, v135, v143
  s_waitcnt lgkmcnt(8)
  v_add_f32 v144, v144, v152
  v_add_f32 v145, v145, v153
  v_add_f32 v146, v146, v154
  v_add_f32 v147, v147, v155
  v_add_f32 v148, v148, v156
  v_add_f32 v149, v149, v157
  v_add_f32 v150, v150, v158
  v_add_f32 v151, v151, v159
  v_add_f32 v128, v128, v144
  v_add_f32 v129, v129, v145
  v_add_f32 v130, v130, v146
  v_add_f32 v131, v131, v147
  v_add_f32 v132, v132, v148
  v_add_f32 v133, v133, v149
  v_add_f32 v134, v134, v150
  v_add_f32 v135, v135, v151
  v_fma_f32 v128, v128, v16, v56
  v_fma_f32 v129, v129, v16, v57
  v_fma_f32 v130, v130, v16, v58
  v_fma_f32 v131, v131, v16, v59
  v_fma_f32 v132, v132, v16, v60
  v_fma_f32 v133, v133, v16, v61
  v_fma_f32 v134, v134, v16, v28
  v_fma_f32 v135, v135, v16, v29
  v_mul_f32 v136, 0xbfb8aa3b, v128
  v_mul_f32 v137, 0xbfb8aa3b, v129
  v_mul_f32 v138, 0xbfb8aa3b, v130
  v_mul_f32 v139, 0xbfb8aa3b, v131
  v_mul_f32 v140, 0xbfb8aa3b, v132
  v_mul_f32 v141, 0xbfb8aa3b, v133
  v_mul_f32 v142, 0xbfb8aa3b, v134
  v_mul_f32 v143, 0xbfb8aa3b, v135
  v_exp_f32 v136, v136
  v_exp_f32 v137, v137
  v_exp_f32 v138, v138
  v_exp_f32 v139, v139
  v_exp_f32 v140, v140
  v_exp_f32 v141, v141
  v_exp_f32 v142, v142
  v_exp_f32 v143, v143
  s_waitcnt lgkmcnt(4)
  v_add_f32 v160, v160, v168
  v_add_f32 v161, v161, v169
  v_add_f32 v162, v162, v170
  v_add_f32 v163, v163, v171
  v_add_f32 v164, v164, v172
  v_add_f32 v165, v165, v173
  v_add_f32 v166, v166, v174
  v_add_f32 v167, v167, v175
  v_add_f32 v136, 1.0, v136
  v_add_f32 v137, 1.0, v137
  v_add_f32 v138, 1.0, v138
  v_add_f32 v139, 1.0, v139
  v_add_f32 v140, 1.0, v140
  v_add_f32 v141, 1.0, v141
  v_add_f32 v142, 1.0, v142
  v_add_f32 v143, 1.0, v143
  v_rcp_f32 v136, v136
  v_rcp_f32 v137, v137
  v_rcp_f32 v138, v138
  v_rcp_f32 v139, v139
  v_rcp_f32 v140, v140
  v_rcp_f32 v141, v141
  v_rcp_f32 v142, v142
  v_rcp_f32 v143, v143
  s_waitcnt lgkmcnt(0)
  v_add_f32 v176, v176, v184
  v_add_f32 v177, v177, v185
  v_add_f32 v178, v178, v186
  v_add_f32 v179, v179, v187
  v_add_f32 v180, v180, v188
  v_add_f32 v181, v181, v189
  v_add_f32 v182, v182, v190
  v_add_f32 v183, v183, v191
  v_add_f32 v160, v160, v176
  v_add_f32 v161, v161, v177
  v_add_f32 v162, v162, v178
  v_add_f32 v163, v163, v179
  v_add_f32 v164, v164, v180
  v_add_f32 v165, v165, v181
  v_add_f32 v166, v166, v182
  v_add_f32 v167, v167, v183
  v_mul_f32 v128, v128, v136
  v_mul_f32 v129, v129, v137
  v_mul_f32 v130, v130, v138
  v_mul_f32 v131, v131, v139
  v_mul_f32 v132, v132, v140
  v_mul_f32 v133, v133, v141
  v_mul_f32 v134, v134, v142
  v_mul_f32 v135, v135, v143
  v_fma_f32 v128, v128, v160, v12
  v_fma_f32 v129, v129, v161, v24
  v_fma_f32 v130, v130, v162, v13
  v_fma_f32 v131, v131, v163, v25
  v_fma_f32 v132, v132, v164, v14
  v_fma_f32 v133, v133, v165, v26
  v_fma_f32 v134, v134, v166, v19
  v_fma_f32 v135, v135, v167, v27
  v_cvt_pk_bf16_f32 v144, v128, v129
  v_cvt_pk_bf16_f32 v145, v130, v131
  v_cvt_pk_bf16_f32 v146, v132, v133
  v_cvt_pk_bf16_f32 v147, v134, v135
  buffer_store_dwordx4 v[144:147], v18, s[48:51], 0 offen nt
L_end:
  s_endpgm
.p2align 8
.rept 64
  s_nop 0
.endr
L_codeend:
.section .rodata,"a"
.p2align 6
.amdhsa_kernel recurrent_scan__sliding_local_dilated__dense_activation_squared_relu__prompt_kernel
  .amdhsa_next_free_vgpr 256
  .amdhsa_next_free_sgpr 102
  .amdhsa_accum_offset 256
  .amdhsa_group_segment_fixed_size 0
  .amdhsa_kernarg_size 88
  .amdhsa_user_sgpr_count 2
  .amdhsa_user_sgpr_kernarg_segment_ptr 1
  .amdhsa_system_sgpr_workgroup_id_x 1
.end_amdhsa_kernel
```
